```python
import torch

def _softmax(x, axis=-1):
    return torch.softmax(x, dim=axis)
def _gelu(x):
    return torch.nn.functional.gelu(x, approximate="tanh")
def _silu(x):
    return torch.nn.functional.silu(x)
def _sigmoid(x):
    return torch.sigmoid(x)
def _layernorm(x, axis=-1, eps=1e-5):
    m = x.mean(dim=axis, keepdim=True)
    v = x.var(dim=axis, keepdim=True, unbiased=False)
    return (x - m) / torch.sqrt(v + eps)
def _scatter_add(tgt, idx, src, axis=0):
    return tgt.clone().index_add_(axis, idx, src)
def _segment_sum(src, seg, n):
    out = torch.zeros((n,) + src.shape[1:], dtype=src.dtype)
    return out.index_add_(0, seg, src)
def _pad(x, pw):
    flat = tuple(v for pair in reversed(pw) for v in pair)
    return torch.nn.functional.pad(x, flat)

kernel_name = 'recurrent_scan__ssm_conv_h3__swiglu_ffn__prompt'

def setup_inputs():

    _w = (lambda a: (lambda t: t.to(torch.bfloat16) if t.is_floating_point() else t)(torch.as_tensor(a)))
    def _A_setup():
        B, S, D = 1, 2048, 448
        ks = 4
        return {
            "q": _w((lambda *s: torch.randn(*s, dtype=torch.bfloat16) * 0.05)(B, S, D)),
            "k": _w((lambda *s: torch.randn(*s, dtype=torch.bfloat16) * 0.2)(B, S, D)),
            "v": _w((lambda *s: torch.randn(*s, dtype=torch.bfloat16) * 0.2)(B, S, D)),
            "shift_k": _w((lambda *s: torch.randn(*s, dtype=torch.bfloat16) * 0.2)(D, ks) * 0.5),
            "ssm_k": _w((lambda *s: torch.randn(*s, dtype=torch.bfloat16) * 0.2)(D, S) * (1.0 / S ** 0.5)),
            "ssm_D": _w((lambda *s: torch.randn(*s, dtype=torch.bfloat16) * 0.2)(D)),
        }
    _A_in = _A_setup()

    def _B_setup():
        B, S, D, F = 1, 2048, 448, 1792
        return {
            "x": _w((lambda *s: torch.randn(*s, dtype=torch.bfloat16) * 0.05)(B, S, D)),
            "w_gate": _w((lambda *s: torch.randn(*s, dtype=torch.bfloat16) * 0.1)(D, F)),
            "w_up": _w((lambda *s: torch.randn(*s, dtype=torch.bfloat16) * 0.1)(D, F)),
            "w_down": _w((lambda *s: torch.randn(*s, dtype=torch.bfloat16) * 0.1)(F, D)),
        }
    _B_in = _B_setup()

    return {
        "A_q": _A_in["q"],
        "A_k": _A_in["k"],
        "A_v": _A_in["v"],
        "A_shift_k": _A_in["shift_k"],
        "A_ssm_k": _A_in["ssm_k"],
        "A_ssm_D": _A_in["ssm_D"],
        "B_x": _B_in["x"],
        "B_w_gate": _B_in["w_gate"],
        "B_w_up": _B_in["w_up"],
        "B_w_down": _B_in["w_down"],
    }

def reference(A_q, A_k, A_v, A_shift_k, A_ssm_k, A_ssm_D, B_x, B_w_gate, B_w_up, B_w_down):
    def _A_ref(q, k, v, shift_k, ssm_k, ssm_D):
        B, S, D = q.shape
        ks = shift_k.shape[-1]
        k_pad = _pad(k, ((0, 0), (ks - 1, 0), (0, 0)))
        k_shift = torch.zeros_like(k)
        for t in range(ks):
            k_shift = k_shift + k_pad[:, t:t + S, :] * shift_k[:, ks - 1 - t][None, None, :]
        kv = k_shift * v
        L = 2 * S
        kv_pad = _pad(kv, ((0, 0), (0, S), (0, 0)))
        kf_pad = _pad(ssm_k, ((0, 0), (0, S)))
        kv_f = (lambda x, axes=(-2,-1): torch.fft.rfft2(x.float(), dim=axes))(kv_pad[:, None, :, :], axes=(1, 2))
        kf_f = (lambda x, axes=(-2,-1): torch.fft.rfft2(x.float(), dim=axes))(kf_pad[:, None, :], axes=(1, 2))
        kf_f = (lambda x, *d: x.permute(*d))(kf_f, 1, 2, 0)
        y_f = kv_f * kf_f[None, :, :, :]
        y = (lambda x, s, axes=(-2,-1): torch.fft.irfft2(x, s=s, dim=axes).to(torch.bfloat16))(y_f, (1, L), axes=(1, 2))[:, 0, :S, :]
        y = y + kv * ssm_D[None, None, :]
        return q * y

    def _B_ref(x, w_gate, w_up, w_down):
        g = _silu(x @ w_gate)
        u = x @ w_up
        return (g * u) @ w_down

    x = A_q
    xn = _layernorm(x, axis=-1)
    s = _A_ref(xn, A_k, A_v, A_shift_k, A_ssm_k, A_ssm_D)
    g = _silu(_B_ref(xn, B_w_gate, B_w_up, B_w_down))
    return x + s * g
```

```asm
; @launch grid=(256,1,1) block=(256,1,1) lds=159744
.amdgcn_target "amdgcn-amd-amdhsa--gfx950"
.text
.globl recurrent_scan__ssm_conv_h3__swiglu_ffn__prompt_kernel
.p2align 12
.p2align 8
.type recurrent_scan__ssm_conv_h3__swiglu_ffn__prompt_kernel,@function
recurrent_scan__ssm_conv_h3__swiglu_ffn__prompt_kernel:
    s_cmp_ge_u32 s2, 256
    s_cbranch_scc1 Lend
    s_load_dwordx16 s[16:31], s[0:1], 0
    s_load_dwordx8 s[32:39], s[0:1], 64
    s_load_dwordx2 s[40:41], s[0:1], 96
    s_getpc_b64 s[42:43]
    s_and_b32 s8, s2, 0xf8
    v_cmp_gt_u32 vcc, 8, v0
    s_nop 0
    s_and_saveexec_b64 s[10:11], vcc
    s_cbranch_execz Lnopf
    v_add_u32_e64 v2, s8, v0
    v_min_u32 v2, 211, v2
    v_lshlrev_b32 v2, 7, v2
    v_mov_b32 v3, s43
    v_add_co_u32 v2, vcc, s42, v2
    s_nop 1
    v_addc_co_u32_e64 v3, vcc, 0, v3, vcc
    global_load_dword v250, v[2:3], off
Lnopf:
    s_mov_b64 exec, s[10:11]
    v_and_b32 v1, 63, v0
    v_lshrrev_b32 v5, 6, v0
    s_nop 0
    v_readfirstlane_b32 s3, v5
    v_lshrrev_b32 v5, 3, v1
    v_and_b32_e64 v6, 7, v1
    v_bfe_u32 v7, v1, 4, 1
    v_lshlrev_b32_e64 v32, 4, v1
    v_mul_u32_u24 v8, 896, v5
    s_cmp_ge_u32 s2, 224
    s_cbranch_scc1 Lhelper
    s_and_b32 s8, s2, 7
    s_lshr_b32 s9, s2, 3
    s_mul_i32 s10, s9, 37
    s_lshr_b32 s10, s10, 8
    s_mul_i32 s11, s10, 7
    s_sub_u32 s5, s9, s11
    s_lshr_b32 s11, s8, 1
    s_and_b32 s12, s8, 1
    s_lshl2_add_u32 s4, s11, s10
    s_lshl1_add_u32 s6, s4, s12
    s_mul_i32 s7, s12, 7
    s_add_u32 s7, s7, s5
    s_lshl_b32 s88, s3, 12
    s_mul_i32 s89, s3, 12288
    s_add_u32 s89, s89, 65536
    s_lshl2_add_u32 s9, s4, s3
    s_mul_i32 s15, s9, 28672
    v_lshrrev_b32 v9, 4, v1
    v_xor_b32 v9, v9, v6
    v_lshlrev_b32 v9, 4, v9
    v_add3_u32 v24, v8, v9, s15
    v_xor_b32_e64 v9, 64, v9
    v_add3_u32 v9, v8, v9, s15
    v_add_u32 v25, 6144, v9
    v_add_u32 v26, 12288, v24
    v_add_u32 v27, 18432, v9
    s_mul_i32 s15, s3, 57344
    s_lshl_b32 s10, s7, 8
    s_add_u32 s15, s15, s10
    v_lshl_add_u32 v13, v8, 2, s15
    v_lshlrev_b32 v9, 1, v7
    v_xor_b32 v9, v9, v6
    v_lshl_add_u32 v20, v9, 4, v13
    v_xor_b32_e64 v22, 64, v20
    v_add_u32 v21, 27648, v20
    v_add_u32 v23, 27648, v22
    s_mov_b32 s46, 1835008
    s_mov_b32 s47, 0x20000
    s_mov_b32 s66, 1605632
    s_mov_b32 s67, 0x20000
    s_mov_b32 s70, 1607680
    s_mov_b32 s71, 0x20000
    s_waitcnt lgkmcnt(0)
    v_mov_b32 v2, s16
    v_mov_b32 v3, s17
    v_writelane_b32 v2, s30, 1
    v_writelane_b32 v3, s31, 1
    v_writelane_b32 v2, s32, 2
    v_writelane_b32 v3, s33, 2
    s_mov_b64 exec, 7
    global_load_dword v249, v[2:3], off
    s_mov_b64 exec, -1
    s_mov_b32 s44, s16
    s_and_b32 s45, s17, 0xffff
    s_mov_b32 s64, s30
    s_and_b32 s65, s31, 0xffff
    s_sub_u32 s68, s32, 2048
    s_subb_u32 s69, s33, 0
    s_add_u32 m0, s88, 0
    s_mov_b32 s91, 0
    buffer_load_dwordx4 v20, s[64:67], s91 offen lds
    buffer_load_dwordx4 v21, s[64:67], s91 offen offset:1024 lds
    buffer_load_dwordx4 v22, s[68:71], s91 offen offset:2048 lds
    buffer_load_dwordx4 v23, s[68:71], s91 offen offset:3072 lds
    s_add_u32 m0, s89, 0
    s_movk_i32 s8, 0
    buffer_load_dwordx4 v24, s[44:47], s8 offen lds
    buffer_load_dwordx4 v25, s[44:47], s8 offen offset:1024 lds
    buffer_load_dwordx4 v26, s[44:47], s8 offen offset:2048 lds
    buffer_load_dwordx4 v27, s[44:47], s8 offen offset:3072 lds
    v_and_b32_e64 v2, 3, v1
    v_bfe_u32 v3, v1, 2, 2
    v_lshrrev_b32 v9, 5, v1
    v_and_b32 v12, 31, v1
    v_lshlrev_b32_e64 v10, 3, v2
    v_lshl_add_u32 v10, v3, 7, v10
    v_lshrrev_b32_e64 v11, 1, v3
    v_lshl_add_u32 v4, v7, 11, v10
    v_lshl_add_u32 v4, v9, 10, v4
    v_lshl_add_u32 v13, v7, 1, v11
    v_xor_b32_e64 v13, s3, v13
    v_lshl_add_u32 v16, v13, 5, v4
    v_xor_b32 v17, 32, v16
    v_xor_b32 v18, 64, v16
    v_xor_b32 v19, 96, v16
    v_bfe_u32 v13, v1, 1, 3
    v_xor_b32_e64 v13, v13, v9
    v_lshl_add_u32 v13, v13, 4, s89
    v_lshl_add_u32 v28, v12, 7, v13
    v_xor_b32 v29, 32, v28
    v_xor_b32 v30, 64, v28
    v_xor_b32 v31, 96, v28
    v_bfe_u32 v13, v1, 1, 3
    v_lshrrev_b32 v4, 4, v1
    v_xor_b32 v13, v13, v4
    v_lshl_add_u32 v13, v13, 4, s89
    v_and_b32_e64 v4, 15, v1
    v_lshl_add_u32 v41, v4, 7, v13
    v_xor_b32 v46, 64, v41
    v_lshrrev_b32 v13, 4, v1
    v_cmp_eq_u32_e64 vcc, v13, v3
    v_mov_b32 v13, 0x3f803f80
    s_nop 0
    v_cndmask_b32 v13, 0, v13, vcc
    v_accvgpr_write_b32 a224, v13
    v_accvgpr_write_b32 a225, v13
    v_accvgpr_write_b32 a226, v13
    v_accvgpr_write_b32 a227, v13
    s_add_u32 m0, s88, 16384
    s_mov_b32 s91, 229376
    buffer_load_dwordx4 v20, s[64:67], s91 offen lds
    buffer_load_dwordx4 v21, s[64:67], s91 offen offset:1024 lds
    buffer_load_dwordx4 v22, s[68:71], s91 offen offset:2048 lds
    buffer_load_dwordx4 v23, s[68:71], s91 offen offset:3072 lds
    s_add_u32 m0, s89, 4096
    s_movk_i32 s8, 128
    buffer_load_dwordx4 v24, s[44:47], s8 offen lds
    buffer_load_dwordx4 v25, s[44:47], s8 offen offset:1024 lds
    buffer_load_dwordx4 v26, s[44:47], s8 offen offset:2048 lds
    buffer_load_dwordx4 v27, s[44:47], s8 offen offset:3072 lds
    s_lshl2_add_u32 s15, s7, s3
    s_mul_i32 s15, s15, 12
    v_min_u32 v4, 11, v1
    v_add_u32_e64 v4, s15, v4
    v_min_u32 v4, 639, v4
    v_and_b32 v13, 127, v4
    v_and_b32 v4, 0x380, v4
    v_mul_u32_u24 v13, 896, v13
    v_add_u32_e64 v4, v4, v13
    s_mul_i32 s15, s4, 114688
    s_mul_i32 s42, s9, 17920
    s_add_u32 s42, s42, s10
    s_add_u32 s42, s42, 458752
    v_min_u32 v13, 4, v1
    v_mul_u32_u24 v13, 3584, v13
    s_mov_b64 exec, 0xffff
    buffer_load_dword v246, v4, s[44:47], s15 offen offset:256
    buffer_load_dword v247, v13, s[64:67], s42 offen
    buffer_load_dword v248, v13, s[68:71], s42 offen offset:2048
    s_mov_b64 exec, -1
    v_mov_b32 v112, 0
    v_mov_b32 v113, 0
    v_mov_b32 v114, 0
    v_mov_b32 v115, 0
    v_mul_u32_u24 v13, 4608, v9
    v_lshl_add_u32 v13, v12, 4, v13
    v_add_u32 v13, 147968, v13
    ds_write_b128 v13, v[112:115]
    s_nop 1
    v_mul_u32_u24 v13, 4160, v5
    v_lshl_add_u32 v13, v6, 2, v13
    v_add_u32 v13, 114688, v13
    ds_write_b32 v13, v112
    s_waitcnt vmcnt(11)
    s_barrier
    ds_read_b128 a[0:3], v28 offset:0
    ds_read_b64_tr_b16 v[56:57], v16 offset:0
    ds_read_b64_tr_b16 v[58:59], v16 offset:512
    ds_read_b128 a[228:231], v41 offset:0
    ds_read_b64_tr_b16 v[72:73], v17 offset:0
    ds_read_b64_tr_b16 v[74:75], v17 offset:512
    ds_read_b64_tr_b16 v[76:77], v18 offset:0
    ds_read_b64_tr_b16 v[78:79], v18 offset:512
    ds_read_b64_tr_b16 v[80:81], v19 offset:0
    ds_read_b64_tr_b16 v[82:83], v19 offset:512
    ds_read_b128 a[4:7], v29 offset:0
    ds_read_b64_tr_b16 v[60:61], v16 offset:4096
    ds_read_b64_tr_b16 v[62:63], v16 offset:4608
    ds_read_b128 a[232:235], v41 offset:2048
    ds_read_b64_tr_b16 v[84:85], v17 offset:4096
    ds_read_b64_tr_b16 v[86:87], v17 offset:4608
    ds_read_b64_tr_b16 v[88:89], v18 offset:4096
    ds_read_b64_tr_b16 v[90:91], v18 offset:4608
    ds_read_b64_tr_b16 v[92:93], v19 offset:4096
    ds_read_b64_tr_b16 v[94:95], v19 offset:4608
    s_waitcnt lgkmcnt(15)
    v_mfma_f32_32x32x16_bf16 v[128:143], v[56:59], a[0:3], 0
    ds_read_b128 a[8:11], v30 offset:0
    ds_read_b64_tr_b16 v[64:65], v16 offset:8192
    ds_read_b64_tr_b16 v[66:67], v16 offset:8704
    s_add_u32 m0, s88, 32768
    s_mov_b32 s91, 458752
    buffer_load_dwordx4 v20, s[64:67], s91 offen lds
    s_mov_b32 s60, s24
    s_and_b32 s61, s25, 0xffff
    s_mov_b32 s62, 1835008
    s_waitcnt lgkmcnt(15)
    v_mfma_f32_32x32x16_bf16 v[144:159], v[72:75], a[0:3], 0
    ds_read_b128 a[236:239], v46 offset:0
    ds_read_b64_tr_b16 v[72:73], v17 offset:8192
    ds_read_b64_tr_b16 v[74:75], v17 offset:8704
    buffer_load_dwordx4 v21, s[64:67], s91 offen offset:1024 lds
    s_mov_b32 s63, 0x20000
    s_mov_b32 s72, s34
    s_and_b32 s73, s35, 0xffff
    s_mov_b32 s74, 1605632
    s_mov_b32 s75, 0x20000
    v_mfma_f32_16x16x32_bf16 v[96:99], a[224:227], a[0:3], 0
    s_lshl_b32 s14, s5, 5
    s_add_u32 s14, s14, s6
    v_mfma_f32_32x32x16_bf16 v[160:175], v[76:79], a[0:3], 0
    ds_read_b64_tr_b16 v[76:77], v18 offset:8192
    ds_read_b64_tr_b16 v[78:79], v18 offset:8704
    buffer_load_dwordx4 v22, s[68:71], s91 offen offset:2048 lds
    s_lshl_b32 s48, s14, 13
    s_mov_b32 s84, s40
    s_and_b32 s85, s41, 0xffff
    s_mov_b32 s86, 16777216
    s_mov_b32 s87, 0x20000
    s_lshl_b32 s42, s3, 10
    v_mfma_f32_16x16x32_bf16 v[100:103], a[228:231], a[228:231], 0
    s_lshl1_add_u32 s51, s42, s48
    s_add_u32 s51, s51, 2097152
    s_waitcnt lgkmcnt(15)
    v_mfma_f32_32x32x16_bf16 v[176:191], v[80:83], a[0:3], 0
    ds_read_b64_tr_b16 v[80:81], v19 offset:8192
    ds_read_b64_tr_b16 v[82:83], v19 offset:8704
    buffer_load_dwordx4 v23, s[68:71], s91 offen offset:3072 lds
    v_mov_b32 v192, -1
    v_mov_b32 v193, -1
    v_mov_b32 v194, -1
    v_mov_b32_e64 v195, -1
    s_mov_b32 s76, s36
    s_and_b32 s77, s37, 0xffff
    v_mfma_f32_16x16x32_bf16 v[42:45], a[224:227], v[56:59], 0
    s_mov_b32 s78, 1835008
    s_mov_b32 s79, 0x20000
    s_waitcnt lgkmcnt(10)
    v_mfma_f32_32x32x16_bf16 v[128:143], v[60:63], a[4:7], v[128:143]
    ds_read_b128 a[12:15], v31 offset:0
    ds_read_b64_tr_b16 v[68:69], v16 offset:12288
    ds_read_b64_tr_b16 v[70:71], v16 offset:12800
    s_add_u32 m0, s89, 8192
    s_movk_i32 s8, 256
    buffer_load_dwordx4 v24, s[44:47], s8 offen lds
    s_mov_b32 s80, s38
    s_and_b32 s81, s39, 0xffff
    s_mov_b32 s82, 256
    v_mfma_f32_32x32x16_bf16 v[144:159], v[84:87], a[4:7], v[144:159]
    ds_read_b128 a[240:243], v46 offset:2048
    ds_read_b64_tr_b16 v[84:85], v17 offset:12288
    ds_read_b64_tr_b16 v[86:87], v17 offset:12800
    buffer_load_dwordx4 v25, s[44:47], s8 offen offset:1024 lds
    s_mov_b32 s83, 0x20000
    s_lshl_b32 s12, s14, 2
    v_mov_b32 v240, s26
    v_mov_b32_e64 v241, s27
    v_mfma_f32_32x32x16_bf16 v[160:175], v[88:91], a[4:7], v[160:175]
    ds_read_b64_tr_b16 v[88:89], v18 offset:12288
    ds_read_b64_tr_b16 v[90:91], v18 offset:12800
    buffer_load_dwordx4 v26, s[44:47], s8 offen offset:2048 lds
    s_add_u32 s16, s26, s12
    s_addc_u32 s17, s27, 0
    v_writelane_b32 v240, s16, 0
    v_writelane_b32 v241, s17, 0
    s_add_u32 s16, s40, 2031616
    s_addc_u32 s17, s41, 0
    v_mfma_f32_32x32x16_bf16 v[176:191], v[92:95], a[4:7], v[176:191]
    ds_read_b64_tr_b16 v[92:93], v19 offset:12288
    ds_read_b64_tr_b16 v[94:95], v19 offset:12800
    buffer_load_dwordx4 v27, s[44:47], s8 offen offset:3072 lds
    v_writelane_b32 v240, s16, 1
    v_writelane_b32 v241, s17, 1
    s_add_u32 s16, s40, 4128768
    s_addc_u32 s17, s41, 0
    v_writelane_b32 v240, s16, 2
    v_writelane_b32 v241, s17, 2
    v_mfma_f32_16x16x32_bf16 v[42:45], a[224:227], v[60:63], v[42:45]
    v_mfma_f32_16x16x32_bf16 v[104:107], a[232:235], a[232:235], 0
    v_mfma_f32_16x16x32_bf16 v[96:99], a[224:227], a[4:7], v[96:99]
    s_waitcnt lgkmcnt(10)
    v_mfma_f32_32x32x16_bf16 v[128:143], v[64:67], a[8:11], v[128:143]
    s_waitcnt vmcnt(11) lgkmcnt(0)
    s_barrier
    ds_read_b128 a[16:19], v28 offset:4096
    ds_read_b64_tr_b16 v[56:57], v16 offset:16384
    ds_read_b64_tr_b16 v[58:59], v16 offset:16896
    s_add_u32 s16, s38, 128
    s_addc_u32 s17, s39, 0
    v_mfma_f32_32x32x16_bf16 v[144:159], v[72:75], a[8:11], v[144:159]
    ds_read_b128 a[228:231], v41 offset:4096
    ds_read_b64_tr_b16 v[72:73], v17 offset:16384
    ds_read_b64_tr_b16 v[74:75], v17 offset:16896
    s_add_u32 m0, s89, 0
    s_movk_i32 s8, 384
    v_mfma_f32_16x16x32_bf16 v[96:99], a[224:227], a[8:11], v[96:99]
    buffer_load_dwordx4 v24, s[44:47], s8 offen lds
    v_writelane_b32 v240, s16, 3
    v_mfma_f32_32x32x16_bf16 v[160:175], v[76:79], a[8:11], v[160:175]
    ds_read_b64_tr_b16 v[76:77], v18 offset:16384
    ds_read_b64_tr_b16 v[78:79], v18 offset:16896
    buffer_load_dwordx4 v25, s[44:47], s8 offen offset:1024 lds
    v_writelane_b32 v241, s17, 3
    s_add_u32 s16, s34, 0
    v_mfma_f32_16x16x32_bf16 v[100:103], a[236:239], a[236:239], v[100:103]
    s_addc_u32 s17, s35, 0
    v_writelane_b32 v240, s16, 4
    v_mfma_f32_32x32x16_bf16 v[176:191], v[80:83], a[8:11], v[176:191]
    ds_read_b64_tr_b16 v[80:81], v19 offset:16384
    ds_read_b64_tr_b16 v[82:83], v19 offset:16896
    v_writelane_b32 v241, s17, 4
    s_add_u32 s16, s24, s48
    s_addc_u32 s17, s25, 0
    v_mfma_f32_16x16x32_bf16 v[42:45], a[224:227], v[64:67], v[42:45]
    v_writelane_b32 v240, s16, 5
    v_writelane_b32 v241, s17, 5
    v_mfma_f32_32x32x16_bf16 v[128:143], v[68:71], a[12:15], v[128:143]
    ds_read_b128 a[20:23], v29 offset:4096
    ds_read_b64_tr_b16 v[60:61], v16 offset:20480
    ds_read_b64_tr_b16 v[62:63], v16 offset:20992
    buffer_load_dwordx4 v26, s[44:47], s8 offen offset:2048 lds
    s_lshl_b32 s15, s14, 7
    v_mfma_f32_32x32x16_bf16 v[144:159], v[84:87], a[12:15], v[144:159]
    ds_read_b128 a[232:235], v41 offset:6144
    ds_read_b64_tr_b16 v[84:85], v17 offset:20480
    ds_read_b64_tr_b16 v[86:87], v17 offset:20992
    s_add_u32 s15, s15, 1966080
    v_mov_b32 v4, s15
    v_mfma_f32_16x16x32_bf16 v[96:99], a[224:227], a[12:15], v[96:99]
    v_cmp_eq_u32 vcc, 0, v0
    v_bfrev_b32 v13, 2
    v_mfma_f32_32x32x16_bf16 v[160:175], v[88:91], a[12:15], v[160:175]
    ds_read_b64_tr_b16 v[88:89], v18 offset:20480
    ds_read_b64_tr_b16 v[90:91], v18 offset:20992
    buffer_load_dwordx4 v27, s[44:47], s8 offen offset:3072 lds
    v_lshlrev_b32_e64 v38, 7, v12
    v_add_u32 v38, 1994752, v38
    v_mfma_f32_16x16x32_bf16 v[104:107], a[240:243], a[240:243], v[104:107]
    v_cndmask_b32 v0, v13, v4, vcc
    v_min_u32 v4, 13, v12
    v_mfma_f32_32x32x16_bf16 v[176:191], v[92:95], a[12:15], v[176:191]
    ds_read_b64_tr_b16 v[92:93], v19 offset:20480
    ds_read_b64_tr_b16 v[94:95], v19 offset:20992
    v_lshrrev_b32 v13, 1, v4
    v_lshlrev_b32 v13, 5, v13
    v_and_b32_e64 v4, 1, v4
    v_mfma_f32_16x16x32_bf16 v[42:45], a[224:227], v[68:71], v[42:45]
    s_lshl_b32 s42, s4, 1
    v_add3_u32 v4, v13, v4, s42
    s_waitcnt lgkmcnt(10)
    v_mfma_f32_32x32x16_bf16 v[128:143], v[56:59], a[16:19], v[128:143]
    ds_read_b128 a[24:27], v30 offset:4096
    ds_read_b64_tr_b16 v[64:65], v16 offset:24576
    ds_read_b64_tr_b16 v[66:67], v16 offset:25088
    s_add_u32 m0, s88, 49152
    s_mov_b32 s91, 688128
    buffer_load_dwordx4 v20, s[64:67], s91 offen lds
    v_mfma_f32_32x32x16_bf16 v[144:159], v[72:75], a[16:19], v[144:159]
    ds_read_b128 a[236:239], v46 offset:4096
    ds_read_b64_tr_b16 v[72:73], v17 offset:24576
    ds_read_b64_tr_b16 v[74:75], v17 offset:25088
    v_lshlrev_b32_e64 v4, 7, v4
    v_add_u32 v39, 1966080, v4
    v_mfma_f32_16x16x32_bf16 v[96:99], a[224:227], a[16:19], v[96:99]
    v_lshlrev_b32 v4, 2, v7
    v_xor_b32 v4, v4, v6
    v_mfma_f32_32x32x16_bf16 v[160:175], v[76:79], a[16:19], v[160:175]
    ds_read_b64_tr_b16 v[76:77], v18 offset:24576
    ds_read_b64_tr_b16 v[78:79], v18 offset:25088
    buffer_load_dwordx4 v21, s[64:67], s91 offen offset:1024 lds
    v_lshl_add_u32 v4, v4, 4, v8
    s_lshl_b32 s15, s5, 7
    v_mfma_f32_16x16x32_bf16 v[100:103], a[228:231], a[228:231], v[100:103]
    s_mul_i32 s42, s3, 14336
    s_add_u32 s15, s15, s42
    v_mfma_f32_32x32x16_bf16 v[176:191], v[80:83], a[16:19], v[176:191]
    ds_read_b64_tr_b16 v[80:81], v19 offset:24576
    ds_read_b64_tr_b16 v[82:83], v19 offset:25088
    v_add_u32_e64 v33, s15, v4
    v_add_u32 v34, 6144, v33
    v_lshl_add_u32 v4, v9, 9, v10
    v_mfma_f32_16x16x32_bf16 v[42:45], a[224:227], v[56:59], v[42:45]
    v_lshl_add_u32 v13, v11, 1, v7
    v_lshl_add_u32 v4, v13, 5, v4
    s_waitcnt lgkmcnt(10)
    v_mfma_f32_32x32x16_bf16 v[128:143], v[60:63], a[20:23], v[128:143]
    ds_read_b128 a[28:31], v31 offset:4096
    ds_read_b64_tr_b16 v[68:69], v16 offset:28672
    ds_read_b64_tr_b16 v[70:71], v16 offset:29184
    buffer_load_dwordx4 v22, s[68:71], s91 offen offset:2048 lds
    v_add_u32 v35, s89, v4
    v_mfma_f32_32x32x16_bf16 v[144:159], v[84:87], a[20:23], v[144:159]
    ds_read_b128 a[240:243], v46 offset:6144
    ds_read_b64_tr_b16 v[84:85], v17 offset:28672
    ds_read_b64_tr_b16 v[86:87], v17 offset:29184
    v_xor_b32_e64 v36, 64, v35
    s_lshr_b32 s15, s3, 1
    v_mfma_f32_32x32x16_bf16 v[160:175], v[88:91], a[20:23], v[160:175]
    ds_read_b64_tr_b16 v[88:89], v18 offset:28672
    ds_read_b64_tr_b16 v[90:91], v18 offset:29184
    buffer_load_dwordx4 v23, s[68:71], s91 offen offset:3072 lds
    s_and_b32 s42, s3, 1
    s_mul_i32 s93, s15, 16640
    v_mfma_f32_32x32x16_bf16 v[176:191], v[92:95], a[20:23], v[176:191]
    ds_read_b64_tr_b16 v[92:93], v19 offset:28672
    ds_read_b64_tr_b16 v[94:95], v19 offset:29184
    s_mul_i32 s50, s42, 8320
    s_add_u32 s50, s50, s93
    s_add_u32 s50, s50, 114736
    v_mfma_f32_16x16x32_bf16 v[42:45], a[224:227], v[60:63], v[42:45]
    v_mfma_f32_16x16x32_bf16 v[104:107], a[232:235], a[232:235], v[104:107]
    v_mfma_f32_16x16x32_bf16 v[96:99], a[224:227], a[20:23], v[96:99]
    s_waitcnt lgkmcnt(10)
    v_mfma_f32_32x32x16_bf16 v[128:143], v[64:67], a[24:27], v[128:143]
    s_waitcnt vmcnt(8) lgkmcnt(0)
    s_barrier
    ds_read_b128 a[32:35], v28 offset:8192
    ds_read_b64_tr_b16 v[56:57], v16 offset:32768
    ds_read_b64_tr_b16 v[58:59], v16 offset:33280
    s_lshl_b32 s49, s15, 12
    s_add_u32 s49, s49, s48
    v_mfma_f32_32x32x16_bf16 v[144:159], v[72:75], a[24:27], v[144:159]
    ds_read_b128 a[228:231], v41 offset:8192
    ds_read_b64_tr_b16 v[72:73], v17 offset:32768
    ds_read_b64_tr_b16 v[74:75], v17 offset:33280
    s_add_u32 m0, s89, 4096
    s_movk_i32 s8, 512
    v_mfma_f32_16x16x32_bf16 v[96:99], a[224:227], a[24:27], v[96:99]
    buffer_load_dwordx4 v24, s[44:47], s8 offen lds
    s_lshl_b32 s43, s42, 2
    v_mfma_f32_32x32x16_bf16 v[160:175], v[76:79], a[24:27], v[160:175]
    ds_read_b64_tr_b16 v[76:77], v18 offset:32768
    ds_read_b64_tr_b16 v[78:79], v18 offset:33280
    buffer_load_dwordx4 v25, s[44:47], s8 offen offset:1024 lds
    s_sub_u32 s49, s49, s43
    s_add_u32 s49, s49, 16
    v_mfma_f32_16x16x32_bf16 v[100:103], a[236:239], a[236:239], v[100:103]
    s_lshl_b32 s42, s42, 8
    s_add_u32 s93, s93, s42
    v_mfma_f32_32x32x16_bf16 v[176:191], v[80:83], a[24:27], v[176:191]
    ds_read_b64_tr_b16 v[80:81], v19 offset:32768
    ds_read_b64_tr_b16 v[82:83], v19 offset:33280
    buffer_load_dwordx4 v26, s[44:47], s8 offen offset:2048 lds
    s_add_u32 s93, s93, 114744
    s_mul_i32 s92, s15, 4608
    v_mfma_f32_16x16x32_bf16 v[42:45], a[224:227], v[64:67], v[42:45]
    s_sub_u32 s92, s92, s42
    s_add_u32 s92, s92, 148256
    v_mfma_f32_32x32x16_bf16 v[128:143], v[68:71], a[28:31], v[128:143]
    ds_read_b128 a[36:39], v29 offset:8192
    ds_read_b64_tr_b16 v[60:61], v16 offset:36864
    ds_read_b64_tr_b16 v[62:63], v16 offset:37376
    v_and_b32 v4, 48, v1
    v_mul_u32_u24 v13, 4160, v3
    v_mfma_f32_32x32x16_bf16 v[144:159], v[84:87], a[28:31], v[144:159]
    ds_read_b128 a[232:235], v41 offset:10240
    ds_read_b64_tr_b16 v[84:85], v17 offset:36864
    ds_read_b64_tr_b16 v[86:87], v17 offset:37376
    buffer_load_dwordx4 v27, s[44:47], s8 offen offset:3072 lds
    v_lshl_add_u32 v13, v2, 3, v13
    v_mfma_f32_16x16x32_bf16 v[96:99], a[224:227], a[28:31], v[96:99]
    v_sub_u32 v13, v13, v4
    v_add_u32 v49, s93, v13
    v_mfma_f32_32x32x16_bf16 v[160:175], v[88:91], a[28:31], v[160:175]
    ds_read_b64_tr_b16 v[88:89], v18 offset:36864
    ds_read_b64_tr_b16 v[90:91], v18 offset:37376
    s_add_u32 m0, s88, 0
    s_mov_b32 s91, 917504
    buffer_load_dwordx4 v20, s[64:67], s91 offen lds
    v_mfma_f32_16x16x32_bf16 v[104:107], a[240:243], a[240:243], v[104:107]
    v_and_b32 v13, 15, v1
    v_lshl_add_u32 v13, v13, 5, v4
    v_mfma_f32_32x32x16_bf16 v[176:191], v[92:95], a[28:31], v[176:191]
    ds_read_b64_tr_b16 v[92:93], v19 offset:36864
    ds_read_b64_tr_b16 v[94:95], v19 offset:37376
    buffer_load_dwordx4 v21, s[64:67], s91 offen offset:1024 lds
    v_add_u32 v50, s92, v13
    s_lshl_b32 s15, s3, 8
    v_mfma_f32_16x16x32_bf16 v[42:45], a[224:227], v[68:71], v[42:45]
    s_add_u32 s15, s15, 158720
    v_lshl_add_u32 v51, v1, 2, s15
    s_waitcnt lgkmcnt(10)
    v_mfma_f32_32x32x16_bf16 v[128:143], v[56:59], a[32:35], v[128:143]
    ds_read_b128 a[40:43], v30 offset:8192
    ds_read_b64_tr_b16 v[64:65], v16 offset:40960
    ds_read_b64_tr_b16 v[66:67], v16 offset:41472
    s_mul_i32 s15, s9, 114688
    s_lshl_b32 s42, s7, 13
    v_mfma_f32_32x32x16_bf16 v[144:159], v[72:75], a[32:35], v[144:159]
    ds_read_b128 a[236:239], v46 offset:8192
    ds_read_b64_tr_b16 v[72:73], v17 offset:40960
    ds_read_b64_tr_b16 v[74:75], v17 offset:41472
    buffer_load_dwordx4 v22, s[68:71], s91 offen offset:2048 lds
    s_add_u32 s15, s15, s42
    v_mfma_f32_16x16x32_bf16 v[96:99], a[224:227], a[32:35], v[96:99]
    s_lshl_b32 s42, s3, 10
    s_add_u32 s15, s15, 4194304
    v_mfma_f32_32x32x16_bf16 v[160:175], v[76:79], a[32:35], v[160:175]
    ds_read_b64_tr_b16 v[76:77], v18 offset:40960
    ds_read_b64_tr_b16 v[78:79], v18 offset:41472
    buffer_load_dwordx4 v23, s[68:71], s91 offen offset:3072 lds
    s_add_u32 s96, s15, s42
    s_nop 0
    s_xor_b32 s97, s96, 1024
    v_mfma_f32_16x16x32_bf16 v[100:103], a[228:231], a[228:231], v[100:103]
    s_xor_b32 s98, s96, 2048
    s_xor_b32 s99, s96, 3072
    v_mfma_f32_32x32x16_bf16 v[176:191], v[80:83], a[32:35], v[176:191]
    ds_read_b64_tr_b16 v[80:81], v19 offset:40960
    ds_read_b64_tr_b16 v[82:83], v19 offset:41472
    s_bfm_b64 exec, 6, 0
    global_load_dword v15, v[240:241], off sc1
    s_mov_b64 exec, -1
    v_mfma_f32_16x16x32_bf16 v[42:45], a[224:227], v[56:59], v[42:45]
    v_mov_b32_e64 v53, 0
    v_mov_b32 v54, 0
    s_waitcnt lgkmcnt(10)
    v_mfma_f32_32x32x16_bf16 v[128:143], v[60:63], a[36:39], v[128:143]
    ds_read_b128 a[44:47], v31 offset:8192
    ds_read_b64_tr_b16 v[68:69], v16 offset:45056
    ds_read_b64_tr_b16 v[70:71], v16 offset:45568
    v_mov_b32 v55, 0
    v_mov_b32 v117, 0
    v_mfma_f32_32x32x16_bf16 v[144:159], v[84:87], a[36:39], v[144:159]
    ds_read_b128 a[240:243], v46 offset:10240
    ds_read_b64_tr_b16 v[84:85], v17 offset:45056
    ds_read_b64_tr_b16 v[86:87], v17 offset:45568
    s_mul_i32 s11, s9, 25088
    s_add_u32 s11, s11, s10
    v_min_u32 v244, 6, v1
    v_mul_u32_u24 v244, 3584, v244
    v_mfma_f32_32x32x16_bf16 v[160:175], v[88:91], a[36:39], v[160:175]
    ds_read_b64_tr_b16 v[88:89], v18 offset:45056
    ds_read_b64_tr_b16 v[90:91], v18 offset:45568
    s_mov_b64 exec, 0xffff
    buffer_load_dword v251, v244, s[64:67], s11 offen offset:128
    buffer_load_dword v252, v244, s[68:71], s11 offen offset:2176
    s_mov_b64 exec, -1
    v_mfma_f32_32x32x16_bf16 v[176:191], v[92:95], a[36:39], v[176:191]
    ds_read_b64_tr_b16 v[92:93], v19 offset:45056
    ds_read_b64_tr_b16 v[94:95], v19 offset:45568
    v_mov_b32 v118, 0
    v_mov_b32_e64 v119, 0
    v_mov_b32 v121, 0
    v_mfma_f32_16x16x32_bf16 v[42:45], a[224:227], v[60:63], v[42:45]
    v_mfma_f32_16x16x32_bf16 v[104:107], a[232:235], a[232:235], v[104:107]
    v_mfma_f32_16x16x32_bf16 v[96:99], a[224:227], a[36:39], v[96:99]
    s_waitcnt lgkmcnt(10)
    v_mfma_f32_32x32x16_bf16 v[128:143], v[64:67], a[40:43], v[128:143]
    s_waitcnt vmcnt(11) lgkmcnt(0)
    s_barrier
    ds_read_b128 a[48:51], v28 offset:0
    ds_read_b64_tr_b16 v[56:57], v16 offset:49152
    ds_read_b64_tr_b16 v[58:59], v16 offset:49664
    v_mov_b32 v122, 0
    v_mov_b32 v123, 0
    v_mfma_f32_32x32x16_bf16 v[144:159], v[72:75], a[40:43], v[144:159]
    ds_read_b128 a[228:231], v41 offset:0
    ds_read_b64_tr_b16 v[72:73], v17 offset:49152
    ds_read_b64_tr_b16 v[74:75], v17 offset:49664
    s_add_u32 m0, s89, 8192
    s_movk_i32 s8, 640
    v_mfma_f32_16x16x32_bf16 v[96:99], a[224:227], a[40:43], v[96:99]
    buffer_load_dwordx4 v24, s[44:47], s8 offen lds
    v_mov_b32 v125, 0
    v_mfma_f32_32x32x16_bf16 v[160:175], v[76:79], a[40:43], v[160:175]
    ds_read_b64_tr_b16 v[76:77], v18 offset:49152
    ds_read_b64_tr_b16 v[78:79], v18 offset:49664
    buffer_load_dwordx4 v25, s[44:47], s8 offen offset:1024 lds
    v_mov_b32 v126, 0
    v_mov_b32 v127, 0
    v_mfma_f32_16x16x32_bf16 v[100:103], a[236:239], a[236:239], v[100:103]
    v_lshlrev_b32 v10, 1, v2
    v_sub_u32 v10, v10, v3
    v_mfma_f32_32x32x16_bf16 v[176:191], v[80:83], a[40:43], v[176:191]
    ds_read_b64_tr_b16 v[80:81], v19 offset:49152
    ds_read_b64_tr_b16 v[82:83], v19 offset:49664
    buffer_load_dwordx4 v26, s[44:47], s8 offen offset:2048 lds
    v_lshlrev_b32_e64 v10, 1, v10
    v_bfe_u32 v11, v1, 2, 3
    v_mfma_f32_16x16x32_bf16 v[42:45], a[224:227], v[64:67], v[42:45]
    v_mul_u32_u24 v11, 4160, v11
    v_lshl_add_u32 v11, v2, 2, v11
    v_mfma_f32_32x32x16_bf16 v[128:143], v[68:71], a[44:47], v[128:143]
    ds_read_b128 a[52:55], v29 offset:0
    ds_read_b64_tr_b16 v[60:61], v16 offset:53248
    ds_read_b64_tr_b16 v[62:63], v16 offset:53760
    v_add_u32 v11, 114720, v11
    v_max_i32_e64 v12, 0, v10
    v_mfma_f32_32x32x16_bf16 v[144:159], v[84:87], a[44:47], v[144:159]
    ds_read_b128 a[232:235], v41 offset:2048
    ds_read_b64_tr_b16 v[84:85], v17 offset:53248
    ds_read_b64_tr_b16 v[86:87], v17 offset:53760
    v_mfma_f32_16x16x32_bf16 v[96:99], a[224:227], a[44:47], v[96:99]
    buffer_load_dwordx4 v27, s[44:47], s8 offen offset:3072 lds
    v_lshl_add_u32 v12, v7, 12, v12
    v_mfma_f32_32x32x16_bf16 v[160:175], v[88:91], a[44:47], v[160:175]
    ds_read_b64_tr_b16 v[88:89], v18 offset:53248
    ds_read_b64_tr_b16 v[90:91], v18 offset:53760
    s_add_u32 m0, s88, 16384
    v_mfma_f32_16x16x32_bf16 v[104:107], a[240:243], a[240:243], v[104:107]
    s_mov_b32 s91, 1146880
    buffer_load_dwordx4 v20, s[64:67], s91 offen lds
    v_mfma_f32_32x32x16_bf16 v[176:191], v[92:95], a[44:47], v[176:191]
    ds_read_b64_tr_b16 v[92:93], v19 offset:53248
    ds_read_b64_tr_b16 v[94:95], v19 offset:53760
    buffer_load_dwordx4 v21, s[64:67], s91 offen offset:1024 lds
    v_mfma_f32_16x16x32_bf16 v[42:45], a[224:227], v[68:71], v[42:45]
    s_waitcnt lgkmcnt(10)
    s_nop 0
    v_mfma_f32_32x32x16_bf16 v[128:143], v[56:59], a[48:51], v[128:143]
    ds_read_b128 a[56:59], v30 offset:0
    ds_read_b64_tr_b16 v[64:65], v16 offset:57344
    ds_read_b64_tr_b16 v[66:67], v16 offset:57856
    v_mfma_f32_32x32x16_bf16 v[144:159], v[72:75], a[48:51], v[144:159]
    ds_read_b128 a[236:239], v46 offset:0
    ds_read_b64_tr_b16 v[72:73], v17 offset:57344
    ds_read_b64_tr_b16 v[74:75], v17 offset:57856
    v_mfma_f32_16x16x32_bf16 v[96:99], a[224:227], a[48:51], v[96:99]
    buffer_load_dwordx4 v22, s[68:71], s91 offen offset:2048 lds
    v_mfma_f32_32x32x16_bf16 v[160:175], v[76:79], a[48:51], v[160:175]
    ds_read_b64_tr_b16 v[76:77], v18 offset:57344
    ds_read_b64_tr_b16 v[78:79], v18 offset:57856
    buffer_load_dwordx4 v23, s[68:71], s91 offen offset:3072 lds
    v_mfma_f32_16x16x32_bf16 v[100:103], a[228:231], a[228:231], v[100:103]
    v_mfma_f32_32x32x16_bf16 v[176:191], v[80:83], a[48:51], v[176:191]
    ds_read_b64_tr_b16 v[80:81], v19 offset:57344
    ds_read_b64_tr_b16 v[82:83], v19 offset:57856
    s_lshl2_add_u32 s12, s6, s3
    s_mul_i32 s12, s12, 12544
    v_mfma_f32_16x16x32_bf16 v[42:45], a[224:227], v[56:59], v[42:45]
    s_lshl_b32 s13, s5, 7
    s_add_u32 s12, s12, s13
    s_waitcnt lgkmcnt(10)
    v_mfma_f32_32x32x16_bf16 v[128:143], v[60:63], a[52:55], v[128:143]
    ds_read_b128 a[60:63], v31 offset:0
    ds_read_b64_tr_b16 v[68:69], v16 offset:61440
    ds_read_b64_tr_b16 v[70:71], v16 offset:61952
    v_mfma_f32_32x32x16_bf16 v[144:159], v[84:87], a[52:55], v[144:159]
    ds_read_b128 a[240:243], v46 offset:2048
    ds_read_b64_tr_b16 v[84:85], v17 offset:61440
    ds_read_b64_tr_b16 v[86:87], v17 offset:61952
    v_min_u32_e64 v245, 13, v1
    v_mul_u32_u24 v245, 896, v245
    s_lshl_b32 s13, s3, 11
    s_add_u32 s13, s13, s48
    v_lshlrev_b32_e64 v243, 7, v1
    v_mfma_f32_32x32x16_bf16 v[160:175], v[88:91], a[52:55], v[160:175]
    ds_read_b64_tr_b16 v[88:89], v18 offset:61440
    ds_read_b64_tr_b16 v[90:91], v18 offset:61952
    s_mov_b64 exec, 0xffff
    buffer_load_dword v253, v245, s[72:75], s12 offen
    buffer_load_dword v254, v243, s[60:63], s13 offen
    s_mov_b64 exec, -1
    v_mfma_f32_32x32x16_bf16 v[176:191], v[92:95], a[52:55], v[176:191]
    ds_read_b64_tr_b16 v[92:93], v19 offset:61440
    ds_read_b64_tr_b16 v[94:95], v19 offset:61952
    v_mfma_f32_16x16x32_bf16 v[42:45], a[224:227], v[60:63], v[42:45]
    v_mfma_f32_16x16x32_bf16 v[104:107], a[232:235], a[232:235], v[104:107]
    v_mfma_f32_16x16x32_bf16 v[96:99], a[224:227], a[52:55], v[96:99]
    s_waitcnt lgkmcnt(10)
    v_mfma_f32_32x32x16_bf16 v[128:143], v[64:67], a[56:59], v[128:143]
    s_waitcnt vmcnt(13) lgkmcnt(0)
    s_barrier
    ds_read_b128 a[64:67], v28 offset:4096
    ds_read_b64_tr_b16 v[56:57], v16 offset:0
    ds_read_b64_tr_b16 v[58:59], v16 offset:512
    s_and_b32 s28, s4, 0
    s_lshl1_add_u32 s28, s28, 0
    v_mfma_f32_32x32x16_bf16 v[144:159], v[72:75], a[56:59], v[144:159]
    ds_read_b128 a[228:231], v41 offset:4096
    ds_read_b64_tr_b16 v[72:73], v17 offset:0
    ds_read_b64_tr_b16 v[74:75], v17 offset:512
    s_add_u32 m0, s89, 0
    v_mfma_f32_16x16x32_bf16 v[96:99], a[224:227], a[56:59], v[96:99]
    s_movk_i32 s8, 768
    buffer_load_dwordx4 v24, s[44:47], s8 offen lds
    v_mfma_f32_32x32x16_bf16 v[160:175], v[76:79], a[56:59], v[160:175]
    ds_read_b64_tr_b16 v[76:77], v18 offset:0
    ds_read_b64_tr_b16 v[78:79], v18 offset:512
    buffer_load_dwordx4 v25, s[44:47], s8 offen offset:1024 lds
    s_cmp_ge_u32 s28, 7
    v_mfma_f32_16x16x32_bf16 v[100:103], a[236:239], a[236:239], v[100:103]
    s_cselect_b32 s29, 7, 0
    s_sub_u32 s28, s28, s29
    v_mfma_f32_32x32x16_bf16 v[176:191], v[80:83], a[56:59], v[176:191]
    ds_read_b64_tr_b16 v[80:81], v19 offset:0
    ds_read_b64_tr_b16 v[82:83], v19 offset:512
    v_mfma_f32_16x16x32_bf16 v[42:45], a[224:227], v[64:67], v[42:45]
    v_mfma_f32_32x32x16_bf16 v[128:143], v[68:71], a[60:63], v[128:143]
    ds_read_b128 a[68:71], v29 offset:4096
    ds_read_b64_tr_b16 v[60:61], v16 offset:4096
    ds_read_b64_tr_b16 v[62:63], v16 offset:4608
    buffer_load_dwordx4 v26, s[44:47], s8 offen offset:2048 lds
    s_lshl_b32 s28, s28, 14
    v_mfma_f32_32x32x16_bf16 v[144:159], v[84:87], a[60:63], v[144:159]
    ds_read_b128 a[232:235], v41 offset:6144
    ds_read_b64_tr_b16 v[84:85], v17 offset:4096
    ds_read_b64_tr_b16 v[86:87], v17 offset:4608
    v_mfma_f32_16x16x32_bf16 v[96:99], a[224:227], a[60:63], v[96:99]
    v_mfma_f32_32x32x16_bf16 v[160:175], v[88:91], a[60:63], v[160:175]
    ds_read_b64_tr_b16 v[88:89], v18 offset:4096
    ds_read_b64_tr_b16 v[90:91], v18 offset:4608
    buffer_load_dwordx4 v27, s[44:47], s8 offen offset:3072 lds
    v_mfma_f32_16x16x32_bf16 v[104:107], a[240:243], a[240:243], v[104:107]
    v_mfma_f32_32x32x16_bf16 v[176:191], v[92:95], a[60:63], v[176:191]
    ds_read_b64_tr_b16 v[92:93], v19 offset:4096
    ds_read_b64_tr_b16 v[94:95], v19 offset:4608
    v_mfma_f32_16x16x32_bf16 v[42:45], a[224:227], v[68:71], v[42:45]
    s_waitcnt lgkmcnt(10)
    s_nop 0
    v_mfma_f32_32x32x16_bf16 v[128:143], v[56:59], a[64:67], v[128:143]
    ds_read_b128 a[72:75], v30 offset:4096
    ds_read_b64_tr_b16 v[64:65], v16 offset:8192
    ds_read_b64_tr_b16 v[66:67], v16 offset:8704
    s_add_u32 m0, s88, 32768
    s_mov_b32 s91, 1376256
    buffer_load_dwordx4 v20, s[64:67], s91 offen lds
    v_mfma_f32_32x32x16_bf16 v[144:159], v[72:75], a[64:67], v[144:159]
    ds_read_b128 a[236:239], v46 offset:4096
    ds_read_b64_tr_b16 v[72:73], v17 offset:8192
    ds_read_b64_tr_b16 v[74:75], v17 offset:8704
    v_mfma_f32_16x16x32_bf16 v[96:99], a[224:227], a[64:67], v[96:99]
    v_mfma_f32_32x32x16_bf16 v[160:175], v[76:79], a[64:67], v[160:175]
    ds_read_b64_tr_b16 v[76:77], v18 offset:8192
    ds_read_b64_tr_b16 v[78:79], v18 offset:8704
    buffer_load_dwordx4 v21, s[64:67], s91 offen offset:1024 lds
    v_mfma_f32_16x16x32_bf16 v[100:103], a[228:231], a[228:231], v[100:103]
    v_mfma_f32_32x32x16_bf16 v[176:191], v[80:83], a[64:67], v[176:191]
    ds_read_b64_tr_b16 v[80:81], v19 offset:8192
    ds_read_b64_tr_b16 v[82:83], v19 offset:8704
    v_mfma_f32_16x16x32_bf16 v[42:45], a[224:227], v[56:59], v[42:45]
    s_waitcnt lgkmcnt(10)
    s_nop 0
    v_mfma_f32_32x32x16_bf16 v[128:143], v[60:63], a[68:71], v[128:143]
    ds_read_b128 a[76:79], v31 offset:4096
    ds_read_b64_tr_b16 v[68:69], v16 offset:12288
    ds_read_b64_tr_b16 v[70:71], v16 offset:12800
    buffer_load_dwordx4 v22, s[68:71], s91 offen offset:2048 lds
    v_mfma_f32_32x32x16_bf16 v[144:159], v[84:87], a[68:71], v[144:159]
    ds_read_b128 a[240:243], v46 offset:6144
    ds_read_b64_tr_b16 v[84:85], v17 offset:12288
    ds_read_b64_tr_b16 v[86:87], v17 offset:12800
    v_mfma_f32_32x32x16_bf16 v[160:175], v[88:91], a[68:71], v[160:175]
    ds_read_b64_tr_b16 v[88:89], v18 offset:12288
    ds_read_b64_tr_b16 v[90:91], v18 offset:12800
    buffer_load_dwordx4 v23, s[68:71], s91 offen offset:3072 lds
    v_mfma_f32_32x32x16_bf16 v[176:191], v[92:95], a[68:71], v[176:191]
    ds_read_b64_tr_b16 v[92:93], v19 offset:12288
    ds_read_b64_tr_b16 v[94:95], v19 offset:12800
    v_mfma_f32_16x16x32_bf16 v[42:45], a[224:227], v[60:63], v[42:45]
    v_mfma_f32_16x16x32_bf16 v[104:107], a[232:235], a[232:235], v[104:107]
    v_mfma_f32_16x16x32_bf16 v[96:99], a[224:227], a[68:71], v[96:99]
    s_waitcnt lgkmcnt(10)
    s_nop 0
    v_mfma_f32_32x32x16_bf16 v[128:143], v[64:67], a[72:75], v[128:143]
    s_waitcnt vmcnt(10) lgkmcnt(0)
    s_barrier
    ds_read_b128 a[80:83], v28 offset:8192
    ds_read_b64_tr_b16 v[56:57], v16 offset:16384
    ds_read_b64_tr_b16 v[58:59], v16 offset:16896
    s_add_u32 s29, s28, 8192
    v_mfma_f32_32x32x16_bf16 v[144:159], v[72:75], a[72:75], v[144:159]
    ds_read_b128 a[228:231], v41 offset:8192
    ds_read_b64_tr_b16 v[72:73], v17 offset:16384
    ds_read_b64_tr_b16 v[74:75], v17 offset:16896
    s_sub_u32 s15, s88, s89
    v_mfma_f32_16x16x32_bf16 v[96:99], a[224:227], a[72:75], v[96:99]
    v_add_u32 v24, s15, v35
    v_add_u32_e64 v25, s15, v36
    v_mfma_f32_32x32x16_bf16 v[160:175], v[76:79], a[72:75], v[160:175]
    ds_read_b64_tr_b16 v[76:77], v18 offset:16384
    ds_read_b64_tr_b16 v[78:79], v18 offset:16896
    v_add_u32 v26, 112640, v33
    v_add_u32 v27, 112640, v34
    s_add_u32 s30, s28, 16384
    v_mfma_f32_16x16x32_bf16 v[100:103], a[236:239], a[236:239], v[100:103]
    s_cmp_eq_u32 s30, 114688
    s_cmov_b32 s30, 0
    s_nop 0
    v_mfma_f32_32x32x16_bf16 v[176:191], v[80:83], a[72:75], v[176:191]
    ds_read_b64_tr_b16 v[80:81], v19 offset:16384
    ds_read_b64_tr_b16 v[82:83], v19 offset:16896
    buffer_load_dword v13, v12, s[60:63], s48 offen
    v_mfma_f32_16x16x32_bf16 v[42:45], a[224:227], v[64:67], v[42:45]
    v_mfma_f32_32x32x16_bf16 v[128:143], v[68:71], a[76:79], v[128:143]
    ds_read_b128 a[84:87], v29 offset:8192
    ds_read_b64_tr_b16 v[60:61], v16 offset:20480
    ds_read_b64_tr_b16 v[62:63], v16 offset:20992
    s_add_u32 m0, s88, 49152
    s_mov_b32 s91, 128
    buffer_load_dwordx4 v20, s[64:67], s91 offen lds
    s_add_u32 s31, s30, 8192
    v_mfma_f32_32x32x16_bf16 v[144:159], v[84:87], a[76:79], v[144:159]
    ds_read_b128 a[232:235], v41 offset:10240
    ds_read_b64_tr_b16 v[84:85], v17 offset:20480
    ds_read_b64_tr_b16 v[86:87], v17 offset:20992
    v_mfma_f32_16x16x32_bf16 v[96:99], a[224:227], a[76:79], v[96:99]
    buffer_load_dwordx4 v21, s[64:67], s91 offen offset:1024 lds
    v_mfma_f32_32x32x16_bf16 v[160:175], v[88:91], a[76:79], v[160:175]
    ds_read_b64_tr_b16 v[88:89], v18 offset:20480
    ds_read_b64_tr_b16 v[90:91], v18 offset:20992
    buffer_load_dwordx4 v22, s[68:71], s91 offen offset:2048 lds
    s_add_u32 s32, s30, 16384
    v_mfma_f32_16x16x32_bf16 v[104:107], a[240:243], a[240:243], v[104:107]
    s_cmp_eq_u32 s32, 114688
    s_cmov_b32 s32, 0
    s_nop 0
    v_mfma_f32_32x32x16_bf16 v[176:191], v[92:95], a[76:79], v[176:191]
    ds_read_b64_tr_b16 v[92:93], v19 offset:20480
    ds_read_b64_tr_b16 v[94:95], v19 offset:20992
    buffer_load_dwordx4 v23, s[68:71], s91 offen offset:3072 lds
    v_mfma_f32_16x16x32_bf16 v[42:45], a[224:227], v[68:71], v[42:45]
    s_waitcnt lgkmcnt(10)
    v_mfma_f32_32x32x16_bf16 v[128:143], v[56:59], a[80:83], v[128:143]
    ds_read_b128 a[88:91], v30 offset:8192
    ds_read_b64_tr_b16 v[64:65], v16 offset:24576
    ds_read_b64_tr_b16 v[66:67], v16 offset:25088
    s_add_u32 m0, s89, 4096
    s_mul_i32 s92, s28, 14
    buffer_load_dwordx4 v33, s[72:75], s92 offen offset:0 lds
    s_add_u32 s33, s32, 8192
    v_mfma_f32_32x32x16_bf16 v[144:159], v[72:75], a[80:83], v[144:159]
    ds_read_b128 a[236:239], v46 offset:8192
    ds_read_b64_tr_b16 v[72:73], v17 offset:24576
    ds_read_b64_tr_b16 v[74:75], v17 offset:25088
    v_mfma_f32_16x16x32_bf16 v[96:99], a[224:227], a[80:83], v[96:99]
    buffer_load_dwordx4 v34, s[72:75], s92 offen offset:1024 lds
    v_mfma_f32_32x32x16_bf16 v[160:175], v[76:79], a[80:83], v[160:175]
    ds_read_b64_tr_b16 v[76:77], v18 offset:24576
    ds_read_b64_tr_b16 v[78:79], v18 offset:25088
    buffer_load_dwordx4 v26, s[72:75], s92 offen offset:2048 lds
    s_add_u32 s34, s32, 16384
    v_mfma_f32_16x16x32_bf16 v[100:103], a[228:231], a[228:231], v[100:103]
    s_cmp_eq_u32 s34, 114688
    s_cmov_b32 s34, 0
    v_mfma_f32_32x32x16_bf16 v[176:191], v[80:83], a[80:83], v[176:191]
    ds_read_b64_tr_b16 v[80:81], v19 offset:24576
    ds_read_b64_tr_b16 v[82:83], v19 offset:25088
    buffer_load_dwordx4 v27, s[72:75], s92 offen offset:3072 lds
    v_mfma_f32_16x16x32_bf16 v[42:45], a[224:227], v[56:59], v[42:45]
    s_waitcnt lgkmcnt(10)
    v_mfma_f32_32x32x16_bf16 v[128:143], v[60:63], a[84:87], v[128:143]
    ds_read_b128 a[92:95], v31 offset:8192
    ds_read_b64_tr_b16 v[68:69], v16 offset:28672
    ds_read_b64_tr_b16 v[70:71], v16 offset:29184
    s_add_u32 m0, s50, 0
    s_nop 0
    buffer_load_dwordx4 v32, s[60:63], s49 offen offset:0 lds
    s_add_u32 s35, s34, 8192
    v_mfma_f32_32x32x16_bf16 v[144:159], v[84:87], a[84:87], v[144:159]
    ds_read_b128 a[240:243], v46 offset:10240
    ds_read_b64_tr_b16 v[84:85], v17 offset:28672
    ds_read_b64_tr_b16 v[86:87], v17 offset:29184
    s_add_u32 m0, s50, 0
    s_nop 0
    buffer_load_dwordx4 v32, s[60:63], s49 offen offset:1024 lds
    v_mfma_f32_32x32x16_bf16 v[160:175], v[88:91], a[84:87], v[160:175]
    ds_read_b64_tr_b16 v[88:89], v18 offset:28672
    ds_read_b64_tr_b16 v[90:91], v18 offset:29184
    s_add_u32 m0, s50, 0
    s_nop 0
    buffer_load_dwordx4 v32, s[60:63], s49 offen offset:2048 lds
    s_add_u32 s36, s34, 16384
    s_cmp_eq_u32 s36, 114688
    s_cmov_b32 s36, 0
    v_mfma_f32_32x32x16_bf16 v[176:191], v[92:95], a[84:87], v[176:191]
    ds_read_b64_tr_b16 v[92:93], v19 offset:28672
    ds_read_b64_tr_b16 v[94:95], v19 offset:29184
    v_mfma_f32_16x16x32_bf16 v[42:45], a[224:227], v[60:63], v[42:45]
    v_mfma_f32_16x16x32_bf16 v[104:107], a[232:235], a[232:235], v[104:107]
    v_mfma_f32_16x16x32_bf16 v[96:99], a[224:227], a[84:87], v[96:99]
    s_waitcnt lgkmcnt(10)
    v_mfma_f32_32x32x16_bf16 v[128:143], v[64:67], a[88:91], v[128:143]
    s_waitcnt vmcnt(12) lgkmcnt(0)
    s_barrier
    ds_read_b128 a[96:99], v28 offset:0
    ds_read_b64_tr_b16 v[56:57], v16 offset:32768
    ds_read_b64_tr_b16 v[58:59], v16 offset:33280
    s_add_u32 s37, s36, 8192
    v_mfma_f32_32x32x16_bf16 v[144:159], v[72:75], a[88:91], v[144:159]
    ds_read_b128 a[228:231], v41 offset:0
    ds_read_b64_tr_b16 v[72:73], v17 offset:32768
    ds_read_b64_tr_b16 v[74:75], v17 offset:33280
    s_add_u32 m0, s88, 0
    v_mfma_f32_16x16x32_bf16 v[96:99], a[224:227], a[88:91], v[96:99]
    s_mov_b32 s91, 229504
    buffer_load_dwordx4 v20, s[64:67], s91 offen lds
    v_mfma_f32_32x32x16_bf16 v[160:175], v[76:79], a[88:91], v[160:175]
    ds_read_b64_tr_b16 v[76:77], v18 offset:32768
    ds_read_b64_tr_b16 v[78:79], v18 offset:33280
    buffer_load_dwordx4 v21, s[64:67], s91 offen offset:1024 lds
    s_add_u32 s38, s36, 16384
    v_mfma_f32_16x16x32_bf16 v[100:103], a[236:239], a[236:239], v[100:103]
    s_cmp_eq_u32 s38, 114688
    s_cmov_b32 s38, 0
    v_mfma_f32_32x32x16_bf16 v[176:191], v[80:83], a[88:91], v[176:191]
    ds_read_b64_tr_b16 v[80:81], v19 offset:32768
    ds_read_b64_tr_b16 v[82:83], v19 offset:33280
    buffer_load_dwordx4 v22, s[68:71], s91 offen offset:2048 lds
    v_mfma_f32_16x16x32_bf16 v[42:45], a[224:227], v[64:67], v[42:45]
    v_mfma_f32_32x32x16_bf16 v[128:143], v[68:71], a[92:95], v[128:143]
    ds_read_b128 a[100:103], v29 offset:0
    ds_read_b64_tr_b16 v[60:61], v16 offset:36864
    ds_read_b64_tr_b16 v[62:63], v16 offset:37376
    buffer_load_dwordx4 v23, s[68:71], s91 offen offset:3072 lds
    s_add_u32 s39, s38, 8192
    v_mfma_f32_32x32x16_bf16 v[144:159], v[84:87], a[92:95], v[144:159]
    ds_read_b128 a[232:235], v41 offset:2048
    ds_read_b64_tr_b16 v[84:85], v17 offset:36864
    ds_read_b64_tr_b16 v[86:87], v17 offset:37376
    s_add_u32 m0, s89, 8192
    v_mfma_f32_16x16x32_bf16 v[96:99], a[224:227], a[92:95], v[96:99]
    s_mul_i32 s92, s30, 14
    s_nop 0
    buffer_load_dwordx4 v33, s[72:75], s92 offen offset:0 lds
    v_mfma_f32_32x32x16_bf16 v[160:175], v[88:91], a[92:95], v[160:175]
    ds_read_b64_tr_b16 v[88:89], v18 offset:36864
    ds_read_b64_tr_b16 v[90:91], v18 offset:37376
    buffer_load_dwordx4 v34, s[72:75], s92 offen offset:1024 lds
    s_add_u32 s40, s38, 16384
    v_mfma_f32_16x16x32_bf16 v[104:107], a[240:243], a[240:243], v[104:107]
    s_cmp_eq_u32 s40, 114688
    s_cmov_b32 s40, 0
    v_mfma_f32_32x32x16_bf16 v[176:191], v[92:95], a[92:95], v[176:191]
    ds_read_b64_tr_b16 v[92:93], v19 offset:36864
    ds_read_b64_tr_b16 v[94:95], v19 offset:37376
    buffer_load_dwordx4 v26, s[72:75], s92 offen offset:2048 lds
    v_mfma_f32_16x16x32_bf16 v[42:45], a[224:227], v[68:71], v[42:45]
    s_waitcnt lgkmcnt(10)
    v_mfma_f32_32x32x16_bf16 v[128:143], v[56:59], a[96:99], v[128:143]
    ds_read_b128 a[104:107], v30 offset:0
    ds_read_b64_tr_b16 v[64:65], v16 offset:40960
    ds_read_b64_tr_b16 v[66:67], v16 offset:41472
    s_add_u32 s41, s40, 8192
    v_and_b32_e64 v108, 15, v1
    v_mfma_f32_32x32x16_bf16 v[144:159], v[72:75], a[96:99], v[144:159]
    ds_read_b128 a[236:239], v46 offset:0
    ds_read_b64_tr_b16 v[72:73], v17 offset:40960
    ds_read_b64_tr_b16 v[74:75], v17 offset:41472
    v_mfma_f32_16x16x32_bf16 v[96:99], a[224:227], a[96:99], v[96:99]
    buffer_load_dwordx4 v27, s[72:75], s92 offen offset:3072 lds
    v_and_b32_e64 v109, 12, v1
    v_mfma_f32_32x32x16_bf16 v[160:175], v[76:79], a[96:99], v[160:175]
    ds_read_b64_tr_b16 v[76:77], v18 offset:40960
    ds_read_b64_tr_b16 v[78:79], v18 offset:41472
    s_add_u32 m0, s50, 0
    s_nop 0
    buffer_load_dwordx4 v32, s[60:63], s49 offen offset:3072 lds
    v_mfma_f32_16x16x32_bf16 v[100:103], a[228:231], a[228:231], v[100:103]
    v_lshl_add_u32 v109, v109, 2, v108
    s_waitcnt vmcnt(20)
    v_lshlrev_b32 v12, 16, v13
    v_mfma_f32_32x32x16_bf16 v[176:191], v[80:83], a[96:99], v[176:191]
    ds_read_b64_tr_b16 v[80:81], v19 offset:40960
    ds_read_b64_tr_b16 v[82:83], v19 offset:41472
    s_add_u32 m0, s50, 4160
    s_sub_u32 s49, s49, 2
    buffer_load_dwordx4 v32, s[60:63], s49 offen offset:0 lds
    v_mfma_f32_16x16x32_bf16 v[42:45], a[224:227], v[56:59], v[42:45]
    v_lshlrev_b32 v109, 2, v109
    v_cmp_gt_i32 vcc, 0, v10
    s_waitcnt lgkmcnt(10)
    v_mfma_f32_32x32x16_bf16 v[128:143], v[60:63], a[100:103], v[128:143]
    ds_read_b128 a[108:111], v31 offset:0
    ds_read_b64_tr_b16 v[68:69], v16 offset:45056
    ds_read_b64_tr_b16 v[70:71], v16 offset:45568
    s_add_u32 m0, s50, 4160
    s_nop 0
    buffer_load_dwordx4 v32, s[60:63], s49 offen offset:1024 lds
    v_cndmask_b32 v13, v13, v12, vcc
    v_mfma_f32_32x32x16_bf16 v[144:159], v[84:87], a[100:103], v[144:159]
    ds_read_b128 a[240:243], v46 offset:2048
    ds_read_b64_tr_b16 v[84:85], v17 offset:45056
    ds_read_b64_tr_b16 v[86:87], v17 offset:45568
    buffer_store_dwordx4 v[192:195], v32, s[84:87], s51 offen offset:0 sc1
    v_cmp_gt_i32_e64 vcc, -2, v10
    v_mfma_f32_32x32x16_bf16 v[160:175], v[88:91], a[100:103], v[160:175]
    ds_read_b64_tr_b16 v[88:89], v18 offset:45056
    ds_read_b64_tr_b16 v[90:91], v18 offset:45568
    buffer_store_dwordx4 v[192:195], v32, s[84:87], s51 offen offset:1024 sc1
    v_cndmask_b32 v13, v13, 0, vcc
    v_mfma_f32_32x32x16_bf16 v[176:191], v[92:95], a[100:103], v[176:191]
    ds_read_b64_tr_b16 v[92:93], v19 offset:45056
    ds_read_b64_tr_b16 v[94:95], v19 offset:45568
    ds_write_b32 v11, v13
    v_mfma_f32_16x16x32_bf16 v[104:107], a[232:235], a[232:235], v[104:107]
    s_waitcnt lgkmcnt(15)
    v_mfma_f32_16x16x32_bf16 v[100:103], a[236:239], a[236:239], v[100:103]
    s_waitcnt lgkmcnt(7)
    v_mfma_f32_16x16x32_bf16 v[104:107], a[240:243], a[240:243], v[104:107]
    v_mfma_f32_16x16x32_bf16 v[42:45], a[224:227], v[60:63], v[42:45]
    v_mfma_f32_16x16x32_bf16 v[42:45], a[224:227], v[64:67], v[42:45]
    v_mfma_f32_16x16x32_bf16 v[42:45], a[224:227], v[68:71], v[42:45]
    v_mfma_f32_16x16x32_bf16 v[96:99], a[224:227], a[100:103], v[96:99]
    v_mfma_f32_16x16x32_bf16 v[96:99], a[224:227], a[104:107], v[96:99]
    v_mfma_f32_16x16x32_bf16 v[96:99], a[224:227], a[108:111], v[96:99]
    v_mfma_f32_32x32x16_bf16 v[128:143], v[64:67], a[104:107], v[128:143]
    s_mov_b32 vcc_lo, 0xaaaaaaaa
    s_mov_b32 vcc_hi, 0xaaaaaaaa
    v_cndmask_b32 v100, v100, v101, vcc
    v_cndmask_b32 v102, v102, v103, vcc
    v_cndmask_b32 v104, v104, v105, vcc
    v_cndmask_b32 v106, v106, v107, vcc
    s_mov_b32 vcc_lo, 0xcccccccc
    s_mov_b32 vcc_hi, 0xcccccccc
    v_cndmask_b32 v100, v100, v102, vcc
    v_cndmask_b32 v104, v104, v106, vcc
    ds_bpermute_b32 v100, v109, v100
    ds_bpermute_b32 v104, v109, v104
    v_cvt_pk_bf16_f32 v43, v42, v42
    v_and_b32 v43, 0xffff0000, v43
    v_sub_f32_e64 v43, v42, v43
    v_cvt_pk_bf16_f32 v4, v42, v43
    ds_write_b32 v51, v4
    s_waitcnt vmcnt(20) lgkmcnt(0)
    s_barrier
    ds_read_b64_tr_b16 v[56:57], v16 offset:49152
    ds_read_b64_tr_b16 v[58:59], v16 offset:49664
    ds_read_b32 v112, v51
    v_permlane32_swap_b32 v96, v97
    v_add_f32 v96, v96, v97
    v_mul_f32 v96, 0x3b124925, v96
    v_mfma_f32_32x32x16_bf16 v[144:159], v[72:75], a[104:107], v[144:159]
    ds_read_b64_tr_b16 v[72:73], v17 offset:49152
    ds_read_b64_tr_b16 v[74:75], v17 offset:49664
    s_add_u32 m0, s88, 16384
    s_mov_b32 s91, 458880
    buffer_load_dwordx4 v20, s[64:67], s91 offen lds
    v_xor_b32 v4, 256, v51
    ds_read_b32 v116, v4
    v_cvt_pk_bf16_f32 v52, -v96, -v96
    s_mov_b32 vcc_lo, 0xffff0000
    s_mov_b32 vcc_hi, 0xffff0000
    v_cndmask_b32_e64 v100, v100, v104, vcc
    v_mfma_f32_32x32x16_bf16 v[160:175], v[76:79], a[104:107], v[160:175]
    ds_read_b64_tr_b16 v[76:77], v18 offset:49152
    ds_read_b64_tr_b16 v[78:79], v18 offset:49664
    buffer_load_dwordx4 v21, s[64:67], s91 offen offset:1024 lds
    v_xor_b32 v4, 512, v51
    ds_read_b32 v120, v4
    v_mul_f32 v100, 0x3b124925, v100
    v_fma_f32 v100, -v96, v96, v100
    v_mfma_f32_32x32x16_bf16 v[176:191], v[80:83], a[104:107], v[176:191]
    ds_read_b64_tr_b16 v[80:81], v19 offset:49152
    ds_read_b64_tr_b16 v[82:83], v19 offset:49664
    v_xor_b32 v4, 768, v51
    ds_read_b32 v124, v4
    v_max_f32_e64 v100, 0, v100
    v_cvt_pk_bf16_f32 v100, v100, v100
    v_mfma_f32_32x32x16_bf16 v[128:143], v[68:71], a[108:111], v[128:143]
    ds_read_b64_tr_b16 v[60:61], v16 offset:53248
    ds_read_b64_tr_b16 v[62:63], v16 offset:53760
    buffer_load_dwordx4 v22, s[68:71], s91 offen offset:2048 lds
    v_and_b32 v100, 0xffff0000, v100
    v_add_f32 v100, 0x3727c5ac, v100
    v_mfma_f32_32x32x16_bf16 v[144:159], v[84:87], a[108:111], v[144:159]
    ds_read_b64_tr_b16 v[84:85], v17 offset:53248
    ds_read_b64_tr_b16 v[86:87], v17 offset:53760
    v_cvt_pk_bf16_f32 v100, v100, v100
    v_and_b32 v100, 0xffff0000, v100
    v_mfma_f32_32x32x16_bf16 v[160:175], v[88:91], a[108:111], v[160:175]
    ds_read_b64_tr_b16 v[88:89], v18 offset:53248
    ds_read_b64_tr_b16 v[90:91], v18 offset:53760
    buffer_load_dwordx4 v23, s[68:71], s91 offen offset:3072 lds
    v_sqrt_f32 v100, v100
    v_and_b32 v5, 31, v1
    v_cvt_pk_bf16_f32 v100, v100, v100
    v_mfma_f32_32x32x16_bf16 v[176:191], v[92:95], a[108:111], v[176:191]
    ds_read_b64_tr_b16 v[92:93], v19 offset:53248
    ds_read_b64_tr_b16 v[94:95], v19 offset:53760
    s_add_u32 m0, s89, 0
    s_mul_i32 s92, s32, 14
    buffer_load_dwordx4 v33, s[72:75], s92 offen offset:0 lds
    v_and_b32 v100, 0xffff0000, v100
    v_rcp_f32 v2, v100
    s_waitcnt lgkmcnt(8)
    v_mfma_f32_32x32x16_bf16 v[128:143], v[112:115], v[52:55], v[128:143]
    v_mul_f32_e64 v48, v100, v100
    v_and_b32 v3, 0xffff0000, v52
    v_mfma_f32_32x32x16_bf16 v[144:159], v[116:119], v[52:55], v[144:159]
    buffer_load_dwordx4 v34, s[72:75], s92 offen offset:1024 lds
    v_mul_f32 v47, 0xbfb8aa3b, v2
    v_mul_f32 v3, v3, v2
    v_mfma_f32_32x32x16_bf16 v[160:175], v[120:123], v[52:55], v[160:175]
    s_lshl_b32 s15, s3, 8
    s_add_u32 s15, s15, 157184
    v_mfma_f32_32x32x16_bf16 v[176:191], v[124:127], v[52:55], v[176:191]
    buffer_load_dwordx4 v26, s[72:75], s92 offen offset:2048 lds
    v_lshl_add_u32 v5, v5, 3, s15
    ds_write_b64 v5, v[2:3]
    v_pk_mul_f32 v[200:201], v[128:129], v[46:47] op_sel:[0,1] op_sel_hi:[1,1]
    v_pk_mul_f32 v[202:203], v[130:131], v[46:47] op_sel:[0,1] op_sel_hi:[1,1]
    v_pk_mul_f32 v[204:205], v[132:133], v[46:47] op_sel:[0,1] op_sel_hi:[1,1]
    buffer_load_dwordx4 v27, s[72:75], s92 offen offset:3072 lds
    v_pk_mul_f32 v[206:207], v[134:135], v[46:47] op_sel:[0,1] op_sel_hi:[1,1]
    v_exp_f32 v200, v200
    v_exp_f32 v201, v201
    v_exp_f32 v202, v202
    v_exp_f32 v203, v203
    v_exp_f32 v204, v204
    v_exp_f32 v205, v205
    v_exp_f32 v206, v206
    v_exp_f32 v207, v207
    v_pk_mul_f32 v[136:137], v[128:129], v[136:137]
    v_pk_mul_f32 v[138:139], v[130:131], v[138:139]
    v_pk_mul_f32 v[140:141], v[132:133], v[140:141]
    v_pk_mul_f32 v[142:143], v[134:135], v[142:143]
    v_pk_fma_f32 v[200:201], v[200:201], v[48:49], v[48:49] op_sel_hi:[1,0,0]
    v_pk_fma_f32 v[202:203], v[202:203], v[48:49], v[48:49] op_sel_hi:[1,0,0]
    v_pk_fma_f32 v[204:205], v[204:205], v[48:49], v[48:49] op_sel_hi:[1,0,0]
    v_pk_fma_f32 v[206:207], v[206:207], v[48:49], v[48:49] op_sel_hi:[1,0,0]
    v_rcp_f32 v200, v200
    v_rcp_f32 v201, v201
    v_rcp_f32 v202, v202
    v_rcp_f32 v203, v203
    v_rcp_f32 v204, v204
    v_rcp_f32 v205, v205
    v_rcp_f32 v206, v206
    v_rcp_f32 v207, v207
    v_pk_mul_f32 v[136:137], v[136:137], v[200:201]
    v_pk_mul_f32 v[138:139], v[138:139], v[202:203]
    v_pk_mul_f32 v[140:141], v[140:141], v[204:205]
    v_pk_mul_f32 v[142:143], v[142:143], v[206:207]
    v_cvt_pk_bf16_f32 v96, v136, v137
    v_cvt_pk_bf16_f32 v97, v138, v139
    v_cvt_pk_bf16_f32 v98, v140, v141
    v_cvt_pk_bf16_f32 v99, v142, v143
    buffer_store_dwordx4 v[96:99], v32, s[84:87], s96 offen sc1
    v_pk_mul_f32 v[208:209], v[144:145], v[46:47] op_sel:[0,1] op_sel_hi:[1,1]
    v_pk_mul_f32 v[210:211], v[146:147], v[46:47] op_sel:[0,1] op_sel_hi:[1,1]
    s_add_u32 m0, s50, 4160
    s_nop 0
    buffer_load_dwordx4 v32, s[60:63], s49 offen offset:2048 lds
    v_pk_mul_f32 v[212:213], v[148:149], v[46:47] op_sel:[0,1] op_sel_hi:[1,1]
    v_pk_mul_f32 v[214:215], v[150:151], v[46:47] op_sel:[0,1] op_sel_hi:[1,1]
    v_exp_f32 v208, v208
    v_exp_f32 v209, v209
    v_exp_f32 v210, v210
    v_exp_f32 v211, v211
    v_exp_f32 v212, v212
    v_exp_f32 v213, v213
    v_exp_f32 v214, v214
    v_exp_f32_e64 v215, v215
    v_pk_mul_f32 v[152:153], v[144:145], v[152:153]
    v_pk_mul_f32 v[154:155], v[146:147], v[154:155]
    v_pk_mul_f32 v[156:157], v[148:149], v[156:157]
    v_pk_mul_f32 v[158:159], v[150:151], v[158:159]
    v_pk_fma_f32 v[208:209], v[208:209], v[48:49], v[48:49] op_sel_hi:[1,0,0]
    v_pk_fma_f32 v[210:211], v[210:211], v[48:49], v[48:49] op_sel_hi:[1,0,0]
    v_pk_fma_f32 v[212:213], v[212:213], v[48:49], v[48:49] op_sel_hi:[1,0,0]
    v_pk_fma_f32 v[214:215], v[214:215], v[48:49], v[48:49] op_sel_hi:[1,0,0]
    v_rcp_f32 v208, v208
    v_rcp_f32 v209, v209
    v_rcp_f32 v210, v210
    v_rcp_f32 v211, v211
    v_rcp_f32 v212, v212
    v_rcp_f32 v213, v213
    v_rcp_f32 v214, v214
    v_rcp_f32 v215, v215
    v_pk_mul_f32 v[152:153], v[152:153], v[208:209]
    v_pk_mul_f32 v[154:155], v[154:155], v[210:211]
    v_pk_mul_f32 v[156:157], v[156:157], v[212:213]
    v_pk_mul_f32 v[158:159], v[158:159], v[214:215]
    v_cvt_pk_bf16_f32 v100, v152, v153
    v_cvt_pk_bf16_f32 v101, v154, v155
    v_cvt_pk_bf16_f32 v102, v156, v157
    v_cvt_pk_bf16_f32 v103, v158, v159
    buffer_store_dwordx4 v[100:103], v32, s[84:87], s97 offen sc1
    v_pk_mul_f32 v[200:201], v[160:161], v[46:47] op_sel:[0,1] op_sel_hi:[1,1]
    v_pk_mul_f32 v[202:203], v[162:163], v[46:47] op_sel:[0,1] op_sel_hi:[1,1]
    s_add_u32 m0, s50, 4160
    s_nop 0
    buffer_load_dwordx4 v32, s[60:63], s49 offen offset:3072 lds
    v_pk_mul_f32 v[204:205], v[164:165], v[46:47] op_sel:[0,1] op_sel_hi:[1,1]
    v_pk_mul_f32 v[206:207], v[166:167], v[46:47] op_sel:[0,1] op_sel_hi:[1,1]
    v_exp_f32 v200, v200
    v_exp_f32 v201, v201
    v_exp_f32 v202, v202
    v_exp_f32 v203, v203
    v_exp_f32 v204, v204
    v_exp_f32 v205, v205
    v_exp_f32 v206, v206
    v_exp_f32_e64 v207, v207
    v_pk_mul_f32 v[168:169], v[160:161], v[168:169]
    v_pk_mul_f32 v[170:171], v[162:163], v[170:171]
    v_pk_mul_f32 v[172:173], v[164:165], v[172:173]
    v_pk_mul_f32 v[174:175], v[166:167], v[174:175]
    v_pk_fma_f32 v[200:201], v[200:201], v[48:49], v[48:49] op_sel_hi:[1,0,0]
    v_pk_fma_f32 v[202:203], v[202:203], v[48:49], v[48:49] op_sel_hi:[1,0,0]
    v_pk_fma_f32 v[204:205], v[204:205], v[48:49], v[48:49] op_sel_hi:[1,0,0]
    v_pk_fma_f32 v[206:207], v[206:207], v[48:49], v[48:49] op_sel_hi:[1,0,0]
    v_rcp_f32 v200, v200
    v_rcp_f32 v201, v201
    v_rcp_f32 v202, v202
    v_rcp_f32 v203, v203
    v_rcp_f32 v204, v204
    v_rcp_f32 v205, v205
    v_rcp_f32 v206, v206
    v_rcp_f32 v207, v207
    v_pk_mul_f32 v[168:169], v[168:169], v[200:201]
    v_pk_mul_f32 v[170:171], v[170:171], v[202:203]
    v_pk_mul_f32 v[172:173], v[172:173], v[204:205]
    v_pk_mul_f32 v[174:175], v[174:175], v[206:207]
    v_cvt_pk_bf16_f32 v104, v168, v169
    v_cvt_pk_bf16_f32 v105, v170, v171
    v_cvt_pk_bf16_f32 v106, v172, v173
    v_cvt_pk_bf16_f32 v107, v174, v175
    buffer_store_dwordx4 v[104:107], v32, s[84:87], s98 offen sc1
    v_pk_mul_f32 v[208:209], v[176:177], v[46:47] op_sel:[0,1] op_sel_hi:[1,1]
    buffer_load_dword v40, off, s[80:83], 0 sc1
    v_pk_mul_f32 v[210:211], v[178:179], v[46:47] op_sel:[0,1] op_sel_hi:[1,1]
    v_pk_mul_f32 v[212:213], v[180:181], v[46:47] op_sel:[0,1] op_sel_hi:[1,1]
    v_pk_mul_f32 v[214:215], v[182:183], v[46:47] op_sel:[0,1] op_sel_hi:[1,1]
    v_exp_f32 v208, v208
    v_exp_f32 v209, v209
    v_exp_f32 v210, v210
    v_exp_f32 v211, v211
    v_exp_f32 v212, v212
    v_exp_f32 v213, v213
    v_exp_f32 v214, v214
    v_exp_f32 v215, v215
    v_pk_mul_f32 v[184:185], v[176:177], v[184:185]
    v_pk_mul_f32 v[186:187], v[178:179], v[186:187]
    v_pk_mul_f32 v[188:189], v[180:181], v[188:189]
    v_pk_mul_f32 v[190:191], v[182:183], v[190:191]
    v_pk_fma_f32 v[208:209], v[208:209], v[48:49], v[48:49] op_sel_hi:[1,0,0]
    v_pk_fma_f32 v[210:211], v[210:211], v[48:49], v[48:49] op_sel_hi:[1,0,0]
    v_pk_fma_f32 v[212:213], v[212:213], v[48:49], v[48:49] op_sel_hi:[1,0,0]
    v_pk_fma_f32 v[214:215], v[214:215], v[48:49], v[48:49] op_sel_hi:[1,0,0]
    v_rcp_f32 v208, v208
    v_rcp_f32 v209, v209
    v_rcp_f32 v210, v210
    v_rcp_f32 v211, v211
    v_rcp_f32 v212, v212
    v_rcp_f32 v213, v213
    v_rcp_f32 v214, v214
    v_rcp_f32 v215, v215
    v_pk_mul_f32 v[184:185], v[184:185], v[208:209]
    v_pk_mul_f32 v[186:187], v[186:187], v[210:211]
    v_pk_mul_f32 v[188:189], v[188:189], v[212:213]
    v_pk_mul_f32 v[190:191], v[190:191], v[214:215]
    v_cvt_pk_bf16_f32 v108, v184, v185
    v_cvt_pk_bf16_f32 v109, v186, v187
    v_cvt_pk_bf16_f32 v110, v188, v189
    v_cvt_pk_bf16_f32 v111, v190, v191
    buffer_store_dwordx4 v[108:111], v32, s[84:87], s99 offen sc1
    v_mfma_f32_32x32x16_bf16 v[192:207], v[56:59], a[0:3], 0
    ds_read_b64_tr_b16 v[64:65], v16 offset:57344
    ds_read_b64_tr_b16 v[66:67], v16 offset:57856
    s_waitcnt vmcnt(31)
    s_nop 0
    ds_read_b64_tr_b16 a[112:113], v35 offset:4096
    ds_read_b64_tr_b16 a[114:115], v35 offset:5120
    v_mfma_f32_32x32x16_bf16 v[208:223], v[72:75], a[0:3], 0
    ds_read_b64_tr_b16 v[72:73], v17 offset:57344
    ds_read_b64_tr_b16 v[74:75], v17 offset:57856
    ds_read_b64_tr_b16 a[116:117], v36 offset:4096
    v_mfma_f32_32x32x16_bf16 v[224:239], v[76:79], a[0:3], 0
    ds_read_b64_tr_b16 v[76:77], v18 offset:57344
    ds_read_b64_tr_b16 v[78:79], v18 offset:57856
    ds_read_b64_tr_b16 a[118:119], v36 offset:5120
    v_mfma_f32_32x32x16_bf16 v[240:255], v[80:83], a[0:3], 0
    ds_read_b64_tr_b16 v[80:81], v19 offset:57344
    ds_read_b64_tr_b16 v[82:83], v19 offset:57856
    ds_read_b64_tr_b16 a[120:121], v35 offset:6144
    s_waitcnt lgkmcnt(14)
    s_nop 0
    v_mfma_f32_32x32x16_bf16 v[192:207], v[60:63], a[4:7], v[192:207]
    ds_read_b64_tr_b16 v[68:69], v16 offset:61440
    ds_read_b64_tr_b16 v[70:71], v16 offset:61952
    ds_read_b64_tr_b16 a[122:123], v35 offset:7168
    v_mfma_f32_32x32x16_bf16 v[208:223], v[84:87], a[4:7], v[208:223]
    ds_read_b64_tr_b16 v[84:85], v17 offset:61440
    ds_read_b64_tr_b16 v[86:87], v17 offset:61952
    ds_read_b64_tr_b16 a[124:125], v36 offset:6144
    v_mfma_f32_32x32x16_bf16 v[224:239], v[88:91], a[4:7], v[224:239]
    ds_read_b64_tr_b16 v[88:89], v18 offset:61440
    ds_read_b64_tr_b16 v[90:91], v18 offset:61952
    ds_read_b64_tr_b16 a[126:127], v36 offset:7168
    v_mfma_f32_32x32x16_bf16 v[240:255], v[92:95], a[4:7], v[240:255]
    ds_read_b64_tr_b16 v[92:93], v19 offset:61440
    ds_read_b64_tr_b16 v[94:95], v19 offset:61952
    v_mfma_f32_16x16x32_bf16 v[42:45], a[224:227], v[56:59], 0
    v_mfma_f32_16x16x32_bf16 v[42:45], a[224:227], v[60:63], v[42:45]
    s_waitcnt lgkmcnt(12)
    s_nop 0
    v_mfma_f32_32x32x16_bf16 v[192:207], v[64:67], a[8:11], v[192:207]
    s_waitcnt vmcnt(24) lgkmcnt(0)
    s_barrier
    ds_read_b64_tr_b16 v[56:57], v16 offset:0
    ds_read_b64_tr_b16 v[58:59], v16 offset:512
    v_mfma_f32_32x32x16_bf16 v[208:223], v[72:75], a[8:11], v[208:223]
    ds_read_b64_tr_b16 v[72:73], v17 offset:0
    ds_read_b64_tr_b16 v[74:75], v17 offset:512
    s_add_u32 m0, s88, 32768
    s_mov_b32 s91, 688256
    buffer_load_dwordx4 v20, s[64:67], s91 offen lds
    v_mfma_f32_32x32x16_bf16 v[224:239], v[76:79], a[8:11], v[224:239]
    ds_read_b64_tr_b16 v[76:77], v18 offset:0
    ds_read_b64_tr_b16 v[78:79], v18 offset:512
    buffer_load_dwordx4 v21, s[64:67], s91 offen offset:1024 lds
    v_mfma_f32_16x16x32_bf16 v[42:45], a[224:227], v[64:67], v[42:45]
    v_mfma_f32_32x32x16_bf16 v[240:255], v[80:83], a[8:11], v[240:255]
    ds_read_b64_tr_b16 v[80:81], v19 offset:0
    ds_read_b64_tr_b16 v[82:83], v19 offset:512
    v_mfma_f32_32x32x16_bf16 v[192:207], v[68:71], a[12:15], v[192:207]
    ds_read_b64_tr_b16 v[60:61], v16 offset:4096
    ds_read_b64_tr_b16 v[62:63], v16 offset:4608
    buffer_load_dwordx4 v22, s[68:71], s91 offen offset:2048 lds
    v_mfma_f32_32x32x16_bf16 v[208:223], v[84:87], a[12:15], v[208:223]
    ds_read_b64_tr_b16 v[84:85], v17 offset:4096
    ds_read_b64_tr_b16 v[86:87], v17 offset:4608
    v_mfma_f32_32x32x16_bf16 v[224:239], v[88:91], a[12:15], v[224:239]
    ds_read_b64_tr_b16 v[88:89], v18 offset:4096
    ds_read_b64_tr_b16 v[90:91], v18 offset:4608
    buffer_load_dwordx4 v23, s[68:71], s91 offen offset:3072 lds
    v_mfma_f32_16x16x32_bf16 v[42:45], a[224:227], v[68:71], v[42:45]
    v_mfma_f32_32x32x16_bf16 v[240:255], v[92:95], a[12:15], v[240:255]
    ds_read_b64_tr_b16 v[92:93], v19 offset:4096
    ds_read_b64_tr_b16 v[94:95], v19 offset:4608
    s_waitcnt lgkmcnt(8)
    s_nop 0
    v_mfma_f32_32x32x16_bf16 v[192:207], v[56:59], a[16:19], v[192:207]
    ds_read_b64_tr_b16 v[64:65], v16 offset:8192
    ds_read_b64_tr_b16 v[66:67], v16 offset:8704
    s_add_u32 m0, s89, 4096
    s_mul_i32 s92, s34, 14
    buffer_load_dwordx4 v33, s[72:75], s92 offen offset:0 lds
    s_waitcnt vmcnt(25)
    ds_read_b64_tr_b16 a[128:129], v35 offset:8192
    ds_read_b64_tr_b16 a[130:131], v35 offset:9216
    v_mfma_f32_32x32x16_bf16 v[208:223], v[72:75], a[16:19], v[208:223]
    ds_read_b64_tr_b16 v[72:73], v17 offset:8192
    ds_read_b64_tr_b16 v[74:75], v17 offset:8704
    ds_read_b64_tr_b16 a[132:133], v36 offset:8192
    v_mfma_f32_32x32x16_bf16 v[224:239], v[76:79], a[16:19], v[224:239]
    ds_read_b64_tr_b16 v[76:77], v18 offset:8192
    ds_read_b64_tr_b16 v[78:79], v18 offset:8704
    buffer_load_dwordx4 v34, s[72:75], s92 offen offset:1024 lds
    ds_read_b64_tr_b16 a[134:135], v36 offset:9216
    v_mfma_f32_32x32x16_bf16 v[240:255], v[80:83], a[16:19], v[240:255]
    ds_read_b64_tr_b16 v[80:81], v19 offset:8192
    ds_read_b64_tr_b16 v[82:83], v19 offset:8704
    ds_read_b64_tr_b16 a[136:137], v35 offset:10240
    s_waitcnt lgkmcnt(13)
    s_nop 0
    v_mfma_f32_32x32x16_bf16 v[192:207], v[60:63], a[20:23], v[192:207]
    ds_read_b64_tr_b16 v[68:69], v16 offset:12288
    ds_read_b64_tr_b16 v[70:71], v16 offset:12800
    buffer_load_dwordx4 v26, s[72:75], s92 offen offset:2048 lds
    ds_read_b64_tr_b16 a[138:139], v35 offset:11264
    v_mfma_f32_32x32x16_bf16 v[208:223], v[84:87], a[20:23], v[208:223]
    ds_read_b64_tr_b16 v[84:85], v17 offset:12288
    ds_read_b64_tr_b16 v[86:87], v17 offset:12800
    ds_read_b64_tr_b16 a[140:141], v36 offset:10240
    v_mfma_f32_32x32x16_bf16 v[224:239], v[88:91], a[20:23], v[224:239]
    ds_read_b64_tr_b16 v[88:89], v18 offset:12288
    ds_read_b64_tr_b16 v[90:91], v18 offset:12800
    buffer_load_dwordx4 v27, s[72:75], s92 offen offset:3072 lds
    ds_read_b64_tr_b16 a[142:143], v36 offset:11264
    v_mfma_f32_32x32x16_bf16 v[240:255], v[92:95], a[20:23], v[240:255]
    ds_read_b64_tr_b16 v[92:93], v19 offset:12288
    ds_read_b64_tr_b16 v[94:95], v19 offset:12800
    v_mfma_f32_16x16x32_bf16 v[42:45], a[224:227], v[56:59], v[42:45]
    v_mfma_f32_16x16x32_bf16 v[42:45], a[224:227], v[60:63], v[42:45]
    s_waitcnt lgkmcnt(12)
    s_nop 0
    v_mfma_f32_32x32x16_bf16 v[192:207], v[64:67], a[24:27], v[192:207]
    s_waitcnt vmcnt(19) lgkmcnt(0)
    s_barrier
    ds_read_b64_tr_b16 v[56:57], v16 offset:16384
    ds_read_b64_tr_b16 v[58:59], v16 offset:16896
    v_mfma_f32_32x32x16_bf16 v[208:223], v[72:75], a[24:27], v[208:223]
    ds_read_b64_tr_b16 v[72:73], v17 offset:16384
    ds_read_b64_tr_b16 v[74:75], v17 offset:16896
    s_waitcnt vmcnt(9)
    v_cmp_gt_u32 vcc, 1, v40
    s_mov_b32 s95, 0
    s_cbranch_vccnz Lslow0
Lback0:
    v_mfma_f32_32x32x16_bf16 v[224:239], v[76:79], a[24:27], v[224:239]
    ds_read_b64_tr_b16 v[76:77], v18 offset:16384
    ds_read_b64_tr_b16 v[78:79], v18 offset:16896
    s_add_u32 m0, s88, 49152
    s_mov_b32 s91, 917632
    v_mfma_f32_16x16x32_bf16 v[42:45], a[224:227], v[64:67], v[42:45]
    buffer_load_dwordx4 v20, s[64:67], s91 offen lds
    s_mul_i32 s15, s6, 229376
    v_mfma_f32_32x32x16_bf16 v[240:255], v[80:83], a[24:27], v[240:255]
    ds_read_b64_tr_b16 v[80:81], v19 offset:16384
    ds_read_b64_tr_b16 v[82:83], v19 offset:16896
    s_lshl_b32 s42, s3, 10
    v_mfma_f32_32x32x16_bf16 v[192:207], v[68:71], a[28:31], v[192:207]
    ds_read_b64_tr_b16 v[60:61], v16 offset:20480
    ds_read_b64_tr_b16 v[62:63], v16 offset:20992
    buffer_load_dwordx4 v21, s[64:67], s91 offen offset:1024 lds
    v_mfma_f32_32x32x16_bf16 v[208:223], v[84:87], a[28:31], v[208:223]
    ds_read_b64_tr_b16 v[84:85], v17 offset:20480
    ds_read_b64_tr_b16 v[86:87], v17 offset:20992
    buffer_load_dwordx4 v22, s[68:71], s91 offen offset:2048 lds
    s_add_u32 s15, s15, s42
    v_mfma_f32_32x32x16_bf16 v[224:239], v[88:91], a[28:31], v[224:239]
    ds_read_b64_tr_b16 v[88:89], v18 offset:20480
    ds_read_b64_tr_b16 v[90:91], v18 offset:20992
    s_add_u32 s15, s15, 4194304
    v_mfma_f32_16x16x32_bf16 v[42:45], a[224:227], v[68:71], v[42:45]
    v_mfma_f32_32x32x16_bf16 v[240:255], v[92:95], a[28:31], v[240:255]
    ds_read_b64_tr_b16 v[92:93], v19 offset:20480
    ds_read_b64_tr_b16 v[94:95], v19 offset:20992
    buffer_load_dwordx4 v23, s[68:71], s91 offen offset:3072 lds
    s_waitcnt lgkmcnt(8)
    v_mfma_f32_32x32x16_bf16 v[192:207], v[56:59], a[32:35], v[192:207]
    ds_read_b64_tr_b16 v[64:65], v16 offset:24576
    ds_read_b64_tr_b16 v[66:67], v16 offset:25088
    s_add_u32 m0, s89, 8192
    s_mul_i32 s92, s36, 14
    buffer_load_dwordx4 v33, s[72:75], s92 offen offset:0 lds
    v_add_u32_e64 v28, s15, v32
    ds_read_b64_tr_b16 a[144:145], v35 offset:0
    ds_read_b64_tr_b16 a[146:147], v35 offset:1024
    v_mfma_f32_32x32x16_bf16 v[208:223], v[72:75], a[32:35], v[208:223]
    ds_read_b64_tr_b16 v[72:73], v17 offset:24576
    ds_read_b64_tr_b16 v[74:75], v17 offset:25088
    v_add_u32 v29, 114688, v28
    ds_read_b64_tr_b16 a[148:149], v36 offset:0
    v_mfma_f32_32x32x16_bf16 v[224:239], v[76:79], a[32:35], v[224:239]
    ds_read_b64_tr_b16 v[76:77], v18 offset:24576
    ds_read_b64_tr_b16 v[78:79], v18 offset:25088
    buffer_load_dwordx4 v34, s[72:75], s92 offen offset:1024 lds
    ds_read_b64_tr_b16 a[150:151], v36 offset:1024
    v_mfma_f32_32x32x16_bf16 v[240:255], v[80:83], a[32:35], v[240:255]
    ds_read_b64_tr_b16 v[80:81], v19 offset:24576
    ds_read_b64_tr_b16 v[82:83], v19 offset:25088
    buffer_load_dwordx4 v26, s[72:75], s92 offen offset:2048 lds
    v_add_u32 v30, 4096, v28
    ds_read_b64_tr_b16 a[152:153], v35 offset:2048
    s_waitcnt lgkmcnt(13)
    s_nop 0
    v_mfma_f32_32x32x16_bf16 v[192:207], v[60:63], a[36:39], v[192:207]
    ds_read_b64_tr_b16 v[68:69], v16 offset:28672
    ds_read_b64_tr_b16 v[70:71], v16 offset:29184
    v_add_u32 v31, 4096, v29
    ds_read_b64_tr_b16 a[154:155], v35 offset:3072
    v_mfma_f32_32x32x16_bf16 v[208:223], v[84:87], a[36:39], v[208:223]
    ds_read_b64_tr_b16 v[84:85], v17 offset:28672
    ds_read_b64_tr_b16 v[86:87], v17 offset:29184
    buffer_load_dwordx4 v27, s[72:75], s92 offen offset:3072 lds
    ds_read_b64_tr_b16 a[156:157], v36 offset:2048
    v_mfma_f32_32x32x16_bf16 v[224:239], v[88:91], a[36:39], v[224:239]
    ds_read_b64_tr_b16 v[88:89], v18 offset:28672
    ds_read_b64_tr_b16 v[90:91], v18 offset:29184
    buffer_load_dword v40, v38, s[84:87], 0 offen sc1
    ds_read_b64_tr_b16 a[158:159], v36 offset:3072
    v_mfma_f32_32x32x16_bf16 v[240:255], v[92:95], a[36:39], v[240:255]
    ds_read_b64_tr_b16 v[92:93], v19 offset:28672
    ds_read_b64_tr_b16 v[94:95], v19 offset:29184
    v_mfma_f32_16x16x32_bf16 v[42:45], a[224:227], v[56:59], v[42:45]
    v_mfma_f32_16x16x32_bf16 v[42:45], a[224:227], v[60:63], v[42:45]
    s_waitcnt lgkmcnt(12)
    v_mfma_f32_32x32x16_bf16 v[192:207], v[64:67], a[40:43], v[192:207]
    s_waitcnt vmcnt(13) lgkmcnt(0)
    s_barrier
    ds_read_b64_tr_b16 v[56:57], v16 offset:32768
    ds_read_b64_tr_b16 v[58:59], v16 offset:33280
    v_lshrrev_b32 v4, 4, v1
    v_lshl_add_u32 v5, v4, 2, v1
    v_mfma_f32_32x32x16_bf16 v[208:223], v[72:75], a[40:43], v[208:223]
    ds_read_b64_tr_b16 v[72:73], v17 offset:32768
    ds_read_b64_tr_b16 v[74:75], v17 offset:33280
    s_add_u32 m0, s88, 0
    s_mov_b32 s91, 1147008
    buffer_load_dwordx4 v20, s[64:67], s91 offen lds
    v_and_b32 v5, 15, v5
    v_mfma_f32_32x32x16_bf16 v[224:239], v[76:79], a[40:43], v[224:239]
    ds_read_b64_tr_b16 v[76:77], v18 offset:32768
    ds_read_b64_tr_b16 v[78:79], v18 offset:33280
    buffer_load_dwordx4 v21, s[64:67], s91 offen offset:1024 lds
    v_mfma_f32_16x16x32_bf16 v[42:45], a[224:227], v[64:67], v[42:45]
    v_lshl_add_u32 v5, v4, 4, v5
    s_lshl_b32 s15, s3, 13
    s_nop 0
    v_mfma_f32_32x32x16_bf16 v[240:255], v[80:83], a[40:43], v[240:255]
    ds_read_b64_tr_b16 v[80:81], v19 offset:32768
    ds_read_b64_tr_b16 v[82:83], v19 offset:33280
    s_add_u32 s15, s15, 114688
    v_mfma_f32_32x32x16_bf16 v[192:207], v[68:71], a[44:47], v[192:207]
    ds_read_b64_tr_b16 v[60:61], v16 offset:36864
    ds_read_b64_tr_b16 v[62:63], v16 offset:37376
    buffer_load_dwordx4 v22, s[68:71], s91 offen offset:2048 lds
    v_lshl_add_u32 v8, v5, 4, s15
    v_mfma_f32_32x32x16_bf16 v[208:223], v[84:87], a[44:47], v[208:223]
    ds_read_b64_tr_b16 v[84:85], v17 offset:36864
    ds_read_b64_tr_b16 v[86:87], v17 offset:37376
    v_and_b32 v4, 3, v1
    v_lshrrev_b32 v5, 2, v1
    v_mfma_f32_32x32x16_bf16 v[224:239], v[88:91], a[44:47], v[224:239]
    ds_read_b64_tr_b16 v[88:89], v18 offset:36864
    ds_read_b64_tr_b16 v[90:91], v18 offset:37376
    buffer_load_dwordx4 v23, s[68:71], s91 offen offset:3072 lds
    v_mfma_f32_16x16x32_bf16 v[42:45], a[224:227], v[68:71], v[42:45]
    v_lshl_add_u32 v5, v4, 2, v5
    v_mfma_f32_32x32x16_bf16 v[240:255], v[92:95], a[44:47], v[240:255]
    ds_read_b64_tr_b16 v[92:93], v19 offset:36864
    ds_read_b64_tr_b16 v[94:95], v19 offset:37376
    v_and_b32 v5, 15, v5
    s_waitcnt lgkmcnt(8)
    v_mfma_f32_32x32x16_bf16 v[192:207], v[56:59], a[48:51], v[192:207]
    ds_read_b64_tr_b16 v[64:65], v16 offset:40960
    ds_read_b64_tr_b16 v[66:67], v16 offset:41472
    s_add_u32 m0, s89, 0
    s_mul_i32 s92, s38, 14
    buffer_load_dwordx4 v33, s[72:75], s92 offen offset:0 lds
    v_lshl_add_u32 v5, v4, 4, v5
    s_lshl_b32 s42, s3, 11
    s_waitcnt vmcnt(14)
    ds_read_b64_tr_b16 a[160:161], v35 offset:4096
    ds_read_b64_tr_b16 a[162:163], v35 offset:5120
    v_mfma_f32_32x32x16_bf16 v[208:223], v[72:75], a[48:51], v[208:223]
    ds_read_b64_tr_b16 v[72:73], v17 offset:40960
    ds_read_b64_tr_b16 v[74:75], v17 offset:41472
    s_add_u32 s15, s42, 114688
    ds_read_b64_tr_b16 a[164:165], v36 offset:4096
    v_mfma_f32_32x32x16_bf16 v[224:239], v[76:79], a[48:51], v[224:239]
    ds_read_b64_tr_b16 v[76:77], v18 offset:40960
    ds_read_b64_tr_b16 v[78:79], v18 offset:41472
    buffer_load_dwordx4 v34, s[72:75], s92 offen offset:1024 lds
    v_lshl_add_u32 v3, v5, 4, s15
    s_lshl_b32 s15, s3, 10
    ds_read_b64_tr_b16 a[166:167], v36 offset:5120
    v_mfma_f32_32x32x16_bf16 v[240:255], v[80:83], a[48:51], v[240:255]
    ds_read_b64_tr_b16 v[80:81], v19 offset:40960
    ds_read_b64_tr_b16 v[82:83], v19 offset:41472
    s_add_u32 s15, s15, 148480
    ds_read_b64_tr_b16 a[168:169], v35 offset:6144
    s_waitcnt lgkmcnt(13)
    v_mfma_f32_32x32x16_bf16 v[192:207], v[60:63], a[52:55], v[192:207]
    ds_read_b64_tr_b16 v[68:69], v16 offset:45056
    ds_read_b64_tr_b16 v[70:71], v16 offset:45568
    buffer_load_dwordx4 v26, s[72:75], s92 offen offset:2048 lds
    v_lshl_add_u32 v7, v1, 3, s15
    ds_read_b64_tr_b16 a[170:171], v35 offset:7168
    v_mfma_f32_32x32x16_bf16 v[208:223], v[84:87], a[52:55], v[208:223]
    ds_read_b64_tr_b16 v[84:85], v17 offset:45056
    ds_read_b64_tr_b16 v[86:87], v17 offset:45568
    v_readfirstlane_b32 s100, v15
    s_nop 0
    v_mov_b32 v10, 0xffff0000
    ds_read_b64_tr_b16 a[172:173], v36 offset:6144
    v_mfma_f32_32x32x16_bf16 v[224:239], v[88:91], a[52:55], v[224:239]
    ds_read_b64_tr_b16 v[88:89], v18 offset:45056
    ds_read_b64_tr_b16 v[90:91], v18 offset:45568
    buffer_load_dwordx4 v27, s[72:75], s92 offen offset:3072 lds
    v_lshlrev_b32_e64 v9, 16, s100
    ds_read_b64_tr_b16 a[174:175], v36 offset:7168
    v_mfma_f32_32x32x16_bf16 v[240:255], v[92:95], a[52:55], v[240:255]
    ds_read_b64_tr_b16 v[92:93], v19 offset:45056
    ds_read_b64_tr_b16 v[94:95], v19 offset:45568
    v_and_b32 v10, s100, v10
    v_mfma_f32_16x16x32_bf16 v[42:45], a[224:227], v[56:59], v[42:45]
    v_mfma_f32_16x16x32_bf16 v[42:45], a[224:227], v[60:63], v[42:45]
    s_waitcnt lgkmcnt(12)
    v_mfma_f32_32x32x16_bf16 v[192:207], v[64:67], a[56:59], v[192:207]
    s_waitcnt vmcnt(13) lgkmcnt(0)
    s_barrier
    ds_read_b64_tr_b16 v[56:57], v16 offset:49152
    ds_read_b64_tr_b16 v[58:59], v16 offset:49664
    v_mfma_f32_32x32x16_bf16 v[208:223], v[72:75], a[56:59], v[208:223]
    ds_read_b64_tr_b16 v[72:73], v17 offset:49152
    ds_read_b64_tr_b16 v[74:75], v17 offset:49664
    v_mov_b32_e64 v2, 2
    buffer_store_dword v2, v0, s[84:87], 0 offen sc1
    v_mfma_f32_32x32x16_bf16 v[224:239], v[76:79], a[56:59], v[224:239]
    ds_read_b64_tr_b16 v[76:77], v18 offset:49152
    ds_read_b64_tr_b16 v[78:79], v18 offset:49664
    s_add_u32 m0, s88, 16384
    v_mfma_f32_16x16x32_bf16 v[42:45], a[224:227], v[64:67], v[42:45]
    s_mov_b32 s91, 1376384
    buffer_load_dwordx4 v20, s[64:67], s91 offen lds
    v_mfma_f32_32x32x16_bf16 v[240:255], v[80:83], a[56:59], v[240:255]
    ds_read_b64_tr_b16 v[80:81], v19 offset:49152
    ds_read_b64_tr_b16 v[82:83], v19 offset:49664
    buffer_load_dwordx4 v21, s[64:67], s91 offen offset:1024 lds
    v_mfma_f32_32x32x16_bf16 v[192:207], v[68:71], a[60:63], v[192:207]
    ds_read_b64_tr_b16 v[60:61], v16 offset:53248
    ds_read_b64_tr_b16 v[62:63], v16 offset:53760
    buffer_load_dwordx4 v22, s[68:71], s91 offen offset:2048 lds
    v_mfma_f32_32x32x16_bf16 v[208:223], v[84:87], a[60:63], v[208:223]
    ds_read_b64_tr_b16 v[84:85], v17 offset:53248
    ds_read_b64_tr_b16 v[86:87], v17 offset:53760
    buffer_load_dwordx4 v23, s[68:71], s91 offen offset:3072 lds
    v_mfma_f32_32x32x16_bf16 v[224:239], v[88:91], a[60:63], v[224:239]
    ds_read_b64_tr_b16 v[88:89], v18 offset:53248
    ds_read_b64_tr_b16 v[90:91], v18 offset:53760
    s_waitcnt vmcnt(13)
    v_cmp_gt_u32_e64 vcc, 1, v40
    s_mov_b32 s95, 0
    v_mfma_f32_16x16x32_bf16 v[42:45], a[224:227], v[68:71], v[42:45]
    s_cbranch_vccnz Lslow1
Lback1:
    v_mfma_f32_32x32x16_bf16 v[240:255], v[92:95], a[60:63], v[240:255]
    ds_read_b64_tr_b16 v[92:93], v19 offset:53248
    ds_read_b64_tr_b16 v[94:95], v19 offset:53760
    s_lshl_b32 s42, s3, 11
    s_add_u32 s15, s48, s42
    s_lshr_b32 s43, s3, 1
    s_lshl_b32 s43, s43, 9
    s_waitcnt lgkmcnt(8)
    v_mfma_f32_32x32x16_bf16 v[192:207], v[56:59], a[64:67], v[192:207]
    ds_read_b64_tr_b16 v[64:65], v16 offset:57344
    ds_read_b64_tr_b16 v[66:67], v16 offset:57856
    ds_read_b64_tr_b16 a[176:177], v35 offset:8192
    ds_read_b64_tr_b16 a[178:179], v35 offset:9216
    v_mfma_f32_32x32x16_bf16 v[208:223], v[72:75], a[64:67], v[208:223]
    ds_read_b64_tr_b16 v[72:73], v17 offset:57344
    ds_read_b64_tr_b16 v[74:75], v17 offset:57856
    s_add_u32 s42, s42, s43
    s_add_u32 m0, s42, 148480
    s_nop 0
    buffer_load_dwordx4 v32, s[84:87], s15 offen sc1 lds
    ds_read_b64_tr_b16 a[180:181], v36 offset:8192
    v_mfma_f32_32x32x16_bf16 v[224:239], v[76:79], a[64:67], v[224:239]
    ds_read_b64_tr_b16 v[76:77], v18 offset:57344
    ds_read_b64_tr_b16 v[78:79], v18 offset:57856
    buffer_load_dwordx4 v32, s[84:87], s15 offen offset:1024 sc1 lds
    ds_read_b64_tr_b16 a[182:183], v36 offset:9216
    v_mfma_f32_32x32x16_bf16 v[240:255], v[80:83], a[64:67], v[240:255]
    ds_read_b64_tr_b16 v[80:81], v19 offset:57344
    ds_read_b64_tr_b16 v[82:83], v19 offset:57856
    s_add_u32 m0, s89, 4096
    s_mul_i32 s92, s40, 14
    buffer_load_dwordx4 v33, s[72:75], s92 offen offset:0 lds
    ds_read_b64_tr_b16 a[184:185], v35 offset:10240
    s_waitcnt lgkmcnt(13)
    v_mfma_f32_32x32x16_bf16 v[192:207], v[60:63], a[68:71], v[192:207]
    ds_read_b64_tr_b16 v[68:69], v16 offset:61440
    ds_read_b64_tr_b16 v[70:71], v16 offset:61952
    buffer_load_dwordx4 v34, s[72:75], s92 offen offset:1024 lds
    ds_read_b64_tr_b16 a[186:187], v35 offset:11264
    v_mfma_f32_32x32x16_bf16 v[208:223], v[84:87], a[68:71], v[208:223]
    ds_read_b64_tr_b16 v[84:85], v17 offset:61440
    ds_read_b64_tr_b16 v[86:87], v17 offset:61952
    buffer_load_dwordx4 v26, s[72:75], s92 offen offset:2048 lds
    ds_read_b64_tr_b16 a[188:189], v36 offset:10240
    v_mfma_f32_32x32x16_bf16 v[224:239], v[88:91], a[68:71], v[224:239]
    ds_read_b64_tr_b16 v[88:89], v18 offset:61440
    ds_read_b64_tr_b16 v[90:91], v18 offset:61952
    buffer_load_dwordx4 v27, s[72:75], s92 offen offset:3072 lds
    ds_read_b64_tr_b16 a[190:191], v36 offset:11264
    v_mfma_f32_32x32x16_bf16 v[240:255], v[92:95], a[68:71], v[240:255]
    ds_read_b64_tr_b16 v[92:93], v19 offset:61440
    ds_read_b64_tr_b16 v[94:95], v19 offset:61952
    v_mfma_f32_16x16x32_bf16 v[42:45], a[224:227], v[56:59], v[42:45]
    v_mfma_f32_16x16x32_bf16 v[42:45], a[224:227], v[60:63], v[42:45]
    s_waitcnt lgkmcnt(12)
    v_mfma_f32_32x32x16_bf16 v[192:207], v[64:67], a[72:75], v[192:207]
    s_waitcnt vmcnt(15) lgkmcnt(0)
    s_barrier
    ds_read_b64_tr_b16 v[56:57], v16 offset:0
    ds_read_b64_tr_b16 v[58:59], v16 offset:512
    v_mfma_f32_32x32x16_bf16 v[208:223], v[72:75], a[72:75], v[208:223]
    ds_read_b64_tr_b16 v[72:73], v17 offset:0
    ds_read_b64_tr_b16 v[74:75], v17 offset:512
    s_add_u32 m0, s88, 32768
    s_mul_i32 s92, s28, 14
    s_add_u32 s92, s92, 57344
    buffer_load_dwordx4 v33, s[72:75], s92 offen offset:0 lds
    v_mfma_f32_32x32x16_bf16 v[224:239], v[76:79], a[72:75], v[224:239]
    ds_read_b64_tr_b16 v[76:77], v18 offset:0
    ds_read_b64_tr_b16 v[78:79], v18 offset:512
    buffer_load_dwordx4 v34, s[72:75], s92 offen offset:1024 lds
    v_mfma_f32_16x16x32_bf16 v[42:45], a[224:227], v[64:67], v[42:45]
    v_mfma_f32_32x32x16_bf16 v[240:255], v[80:83], a[72:75], v[240:255]
    ds_read_b64_tr_b16 v[80:81], v19 offset:0
    ds_read_b64_tr_b16 v[82:83], v19 offset:512
    v_mfma_f32_32x32x16_bf16 v[192:207], v[68:71], a[76:79], v[192:207]
    ds_read_b64_tr_b16 v[60:61], v16 offset:4096
    ds_read_b64_tr_b16 v[62:63], v16 offset:4608
    buffer_load_dwordx4 v26, s[72:75], s92 offen offset:2048 lds
    v_mfma_f32_32x32x16_bf16 v[208:223], v[84:87], a[76:79], v[208:223]
    ds_read_b64_tr_b16 v[84:85], v17 offset:4096
    ds_read_b64_tr_b16 v[86:87], v17 offset:4608
    v_mfma_f32_32x32x16_bf16 v[224:239], v[88:91], a[76:79], v[224:239]
    ds_read_b64_tr_b16 v[88:89], v18 offset:4096
    ds_read_b64_tr_b16 v[90:91], v18 offset:4608
    buffer_load_dwordx4 v27, s[72:75], s92 offen offset:3072 lds
    v_mfma_f32_16x16x32_bf16 v[42:45], a[224:227], v[68:71], v[42:45]
    v_mfma_f32_32x32x16_bf16 v[240:255], v[92:95], a[76:79], v[240:255]
    ds_read_b64_tr_b16 v[92:93], v19 offset:4096
    ds_read_b64_tr_b16 v[94:95], v19 offset:4608
    s_waitcnt lgkmcnt(8)
    s_nop 0
    v_mfma_f32_32x32x16_bf16 v[192:207], v[56:59], a[80:83], v[192:207]
    ds_read_b64_tr_b16 v[64:65], v16 offset:8192
    ds_read_b64_tr_b16 v[66:67], v16 offset:8704
    s_add_u32 m0, s88, 49152
    s_mul_i32 s92, s30, 14
    s_add_u32 s92, s92, 57344
    buffer_load_dwordx4 v33, s[72:75], s92 offen offset:0 lds
    s_waitcnt vmcnt(16)
    ds_read_b64_tr_b16 a[192:193], v35 offset:0
    ds_read_b64_tr_b16 a[194:195], v35 offset:1024
    v_mfma_f32_32x32x16_bf16 v[208:223], v[72:75], a[80:83], v[208:223]
    ds_read_b64_tr_b16 v[72:73], v17 offset:8192
    ds_read_b64_tr_b16 v[74:75], v17 offset:8704
    ds_read_b64_tr_b16 a[196:197], v36 offset:0
    v_mfma_f32_32x32x16_bf16 v[224:239], v[76:79], a[80:83], v[224:239]
    ds_read_b64_tr_b16 v[76:77], v18 offset:8192
    ds_read_b64_tr_b16 v[78:79], v18 offset:8704
    buffer_load_dwordx4 v34, s[72:75], s92 offen offset:1024 lds
    ds_read_b64_tr_b16 a[198:199], v36 offset:1024
    v_mfma_f32_32x32x16_bf16 v[240:255], v[80:83], a[80:83], v[240:255]
    ds_read_b64_tr_b16 v[80:81], v19 offset:8192
    ds_read_b64_tr_b16 v[82:83], v19 offset:8704
    ds_read_b64_tr_b16 a[200:201], v35 offset:2048
    s_waitcnt lgkmcnt(13)
    s_nop 0
    v_mfma_f32_32x32x16_bf16 v[192:207], v[60:63], a[84:87], v[192:207]
    ds_read_b64_tr_b16 v[68:69], v16 offset:12288
    ds_read_b64_tr_b16 v[70:71], v16 offset:12800
    buffer_load_dwordx4 v26, s[72:75], s92 offen offset:2048 lds
    ds_read_b64_tr_b16 a[202:203], v35 offset:3072
    v_mfma_f32_32x32x16_bf16 v[208:223], v[84:87], a[84:87], v[208:223]
    ds_read_b64_tr_b16 v[84:85], v17 offset:12288
    ds_read_b64_tr_b16 v[86:87], v17 offset:12800
    ds_read_b64_tr_b16 a[204:205], v36 offset:2048
    v_mfma_f32_32x32x16_bf16 v[224:239], v[88:91], a[84:87], v[224:239]
    ds_read_b64_tr_b16 v[88:89], v18 offset:12288
    ds_read_b64_tr_b16 v[90:91], v18 offset:12800
    buffer_load_dwordx4 v27, s[72:75], s92 offen offset:3072 lds
    ds_read_b64_tr_b16 a[206:207], v36 offset:3072
    v_mfma_f32_32x32x16_bf16 v[240:255], v[92:95], a[84:87], v[240:255]
    ds_read_b64_tr_b16 v[92:93], v19 offset:12288
    ds_read_b64_tr_b16 v[94:95], v19 offset:12800
    v_mfma_f32_16x16x32_bf16 v[42:45], a[224:227], v[56:59], v[42:45]
    v_mfma_f32_16x16x32_bf16 v[42:45], a[224:227], v[60:63], v[42:45]
    s_waitcnt lgkmcnt(12)
    v_mfma_f32_32x32x16_bf16 v[192:207], v[64:67], a[88:91], v[192:207]
    s_waitcnt vmcnt(14) lgkmcnt(0)
    s_barrier
    ds_read_b64_tr_b16 v[56:57], v16 offset:16384
    ds_read_b64_tr_b16 v[58:59], v16 offset:16896
    v_mfma_f32_32x32x16_bf16 v[208:223], v[72:75], a[88:91], v[208:223]
    ds_read_b64_tr_b16 v[72:73], v17 offset:16384
    ds_read_b64_tr_b16 v[74:75], v17 offset:16896
    s_add_u32 m0, s89, 8192
    s_mul_i32 s92, s32, 14
    s_add_u32 s92, s92, 57344
    buffer_load_dwordx4 v33, s[72:75], s92 offen offset:0 lds
    v_mfma_f32_32x32x16_bf16 v[224:239], v[76:79], a[88:91], v[224:239]
    ds_read_b64_tr_b16 v[76:77], v18 offset:16384
    ds_read_b64_tr_b16 v[78:79], v18 offset:16896
    buffer_load_dwordx4 v34, s[72:75], s92 offen offset:1024 lds
    v_mfma_f32_16x16x32_bf16 v[42:45], a[224:227], v[64:67], v[42:45]
    v_mfma_f32_32x32x16_bf16 v[240:255], v[80:83], a[88:91], v[240:255]
    ds_read_b64_tr_b16 v[80:81], v19 offset:16384
    ds_read_b64_tr_b16 v[82:83], v19 offset:16896
    v_mfma_f32_32x32x16_bf16 v[192:207], v[68:71], a[92:95], v[192:207]
    ds_read_b64_tr_b16 v[60:61], v16 offset:20480
    ds_read_b64_tr_b16 v[62:63], v16 offset:20992
    buffer_load_dwordx4 v26, s[72:75], s92 offen offset:2048 lds
    v_mfma_f32_32x32x16_bf16 v[208:223], v[84:87], a[92:95], v[208:223]
    ds_read_b64_tr_b16 v[84:85], v17 offset:20480
    ds_read_b64_tr_b16 v[86:87], v17 offset:20992
    buffer_load_dwordx4 v27, s[72:75], s92 offen offset:3072 lds
    v_mfma_f32_32x32x16_bf16 v[224:239], v[88:91], a[92:95], v[224:239]
    ds_read_b64_tr_b16 v[88:89], v18 offset:20480
    ds_read_b64_tr_b16 v[90:91], v18 offset:20992
    v_mfma_f32_16x16x32_bf16 v[42:45], a[224:227], v[68:71], v[42:45]
    v_mfma_f32_32x32x16_bf16 v[240:255], v[92:95], a[92:95], v[240:255]
    ds_read_b64_tr_b16 v[92:93], v19 offset:20480
    ds_read_b64_tr_b16 v[94:95], v19 offset:20992
    s_add_u32 m0, s88, 0
    s_mul_i32 s92, s34, 14
    s_add_u32 s92, s92, 57344
    buffer_load_dwordx4 v33, s[72:75], s92 offen offset:0 lds
    s_waitcnt lgkmcnt(8)
    v_mfma_f32_32x32x16_bf16 v[192:207], v[56:59], a[96:99], v[192:207]
    ds_read_b64_tr_b16 v[64:65], v16 offset:24576
    ds_read_b64_tr_b16 v[66:67], v16 offset:25088
    buffer_load_dwordx4 v34, s[72:75], s92 offen offset:1024 lds
    s_waitcnt vmcnt(14)
    ds_read_b64_tr_b16 a[208:209], v35 offset:4096
    ds_read_b64_tr_b16 a[210:211], v35 offset:5120
    v_mfma_f32_32x32x16_bf16 v[208:223], v[72:75], a[96:99], v[208:223]
    ds_read_b64_tr_b16 v[72:73], v17 offset:24576
    ds_read_b64_tr_b16 v[74:75], v17 offset:25088
    ds_read_b64_tr_b16 a[212:213], v36 offset:4096
    v_mfma_f32_32x32x16_bf16 v[224:239], v[76:79], a[96:99], v[224:239]
    ds_read_b64_tr_b16 v[76:77], v18 offset:24576
    ds_read_b64_tr_b16 v[78:79], v18 offset:25088
    buffer_load_dwordx4 v26, s[72:75], s92 offen offset:2048 lds
    ds_read_b64_tr_b16 a[214:215], v36 offset:5120
    v_mfma_f32_32x32x16_bf16 v[240:255], v[80:83], a[96:99], v[240:255]
    ds_read_b64_tr_b16 v[80:81], v19 offset:24576
    ds_read_b64_tr_b16 v[82:83], v19 offset:25088
    buffer_load_dwordx4 v27, s[72:75], s92 offen offset:3072 lds
    ds_read_b64_tr_b16 a[216:217], v35 offset:6144
    s_waitcnt lgkmcnt(13)
    s_nop 0
    v_mfma_f32_32x32x16_bf16 v[192:207], v[60:63], a[100:103], v[192:207]
    ds_read_b64_tr_b16 v[68:69], v16 offset:28672
    ds_read_b64_tr_b16 v[70:71], v16 offset:29184
    ds_read_b64_tr_b16 a[218:219], v35 offset:7168
    v_mfma_f32_32x32x16_bf16 v[208:223], v[84:87], a[100:103], v[208:223]
    ds_read_b64_tr_b16 v[84:85], v17 offset:28672
    ds_read_b64_tr_b16 v[86:87], v17 offset:29184
    s_lshl_b32 s15, s5, 12
    s_sub_u32 s15, s15, 28672
    v_add_u32 v38, s15, v38
    ds_read_b64_tr_b16 a[220:221], v36 offset:6144
    v_mfma_f32_32x32x16_bf16 v[224:239], v[88:91], a[100:103], v[224:239]
    ds_read_b64_tr_b16 v[88:89], v18 offset:28672
    ds_read_b64_tr_b16 v[90:91], v18 offset:29184
    v_cmp_gt_u32 vcc, 32, v1
    s_nop 1
    v_cndmask_b32_e64 v38, v38, v39, vcc
    v_cndmask_b32 v37, 2, 3, vcc
    ds_read_b64_tr_b16 a[222:223], v36 offset:7168
    v_mfma_f32_32x32x16_bf16 v[240:255], v[92:95], a[100:103], v[240:255]
    ds_read_b64_tr_b16 v[92:93], v19 offset:28672
    ds_read_b64_tr_b16 v[94:95], v19 offset:29184
    v_mfma_f32_16x16x32_bf16 v[42:45], a[224:227], v[56:59], v[42:45]
    v_mfma_f32_16x16x32_bf16 v[42:45], a[224:227], v[60:63], v[42:45]
    s_waitcnt lgkmcnt(12)
    v_mfma_f32_32x32x16_bf16 v[192:207], v[64:67], a[104:107], v[192:207]
    s_waitcnt lgkmcnt(0)
    s_barrier
    v_mfma_f32_16x16x32_bf16 v[42:45], a[224:227], v[64:67], v[42:45]
    v_mfma_f32_16x16x32_bf16 v[42:45], a[224:227], v[68:71], v[42:45]
    v_mfma_f32_32x32x16_bf16 v[208:223], v[72:75], a[104:107], v[208:223]
    s_nop 6
    v_cvt_pk_bf16_f32 v43, v42, v42
    v_and_b32 v43, 0xffff0000, v43
    v_sub_f32_e64 v43, v42, v43
    v_cvt_pk_bf16_f32 v4, v42, v43
    ds_write_b32 v51, v4
    s_add_u32 m0, s89, 0
    s_mul_i32 s92, s36, 14
    s_add_u32 s92, s92, 57344
    buffer_load_dwordx4 v33, s[72:75], s92 offen offset:0 lds
    v_mfma_f32_32x32x16_bf16 v[224:239], v[76:79], a[104:107], v[224:239]
    buffer_load_dwordx4 v34, s[72:75], s92 offen offset:1024 lds
    v_mfma_f32_32x32x16_bf16 v[240:255], v[80:83], a[104:107], v[240:255]
    buffer_load_dwordx4 v26, s[72:75], s92 offen offset:2048 lds
    v_mfma_f32_32x32x16_bf16 v[192:207], v[68:71], a[108:111], v[192:207]
    s_waitcnt lgkmcnt(0)
    s_barrier
    ds_read_b32 v112, v51
    v_xor_b32 v4, 256, v51
    ds_read_b32 v116, v4
    v_xor_b32 v4, 512, v51
    ds_read_b32 v120, v4
    v_xor_b32 v4, 768, v51
    ds_read_b32 v124, v4
    buffer_load_dwordx4 v27, s[72:75], s92 offen offset:3072 lds
    v_mfma_f32_32x32x16_bf16 v[208:223], v[84:87], a[108:111], v[208:223]
    s_add_u32 m0, s88, 16384
    s_mul_i32 s92, s38, 14
    s_add_u32 s92, s92, 57344
    buffer_load_dwordx4 v33, s[72:75], s92 offen offset:0 lds
    v_mfma_f32_32x32x16_bf16 v[224:239], v[88:91], a[108:111], v[224:239]
    v_mfma_f32_32x32x16_bf16 v[240:255], v[92:95], a[108:111], v[240:255]
    buffer_load_dwordx4 v34, s[72:75], s92 offen offset:1024 lds
    s_waitcnt lgkmcnt(0)
    v_mfma_f32_32x32x16_bf16 v[192:207], v[112:115], v[52:55], v[192:207]
    buffer_load_dwordx4 v26, s[72:75], s92 offen offset:2048 lds
    v_mfma_f32_32x32x16_bf16 v[208:223], v[116:119], v[52:55], v[208:223]
    buffer_load_dwordx4 v27, s[72:75], s92 offen offset:3072 lds
    v_mfma_f32_32x32x16_bf16 v[224:239], v[120:123], v[52:55], v[224:239]
    s_add_u32 s96, s96, 4096
    s_add_u32 s97, s97, 4096
    s_add_u32 s98, s98, 4096
    s_add_u32 s99, s99, 4096
    v_mfma_f32_32x32x16_bf16 v[240:255], v[124:127], v[52:55], v[240:255]
    ds_read_b128 v[160:163], v50 offset:192
    ds_read_b64_tr_b16 v[128:129], v49 offset:8
    ds_read_b64_tr_b16 v[130:131], v49 offset:0
    ds_read_b128 v[164:167], v50 offset:704
    ds_read_b64_tr_b16 v[132:133], v49 offset:520
    ds_read_b64_tr_b16 v[134:135], v49 offset:512
    v_pk_mul_f32 v[112:113], v[192:193], v[46:47] op_sel:[0,1] op_sel_hi:[1,1]
    v_pk_mul_f32 v[114:115], v[194:195], v[46:47] op_sel:[0,1] op_sel_hi:[1,1]
    v_pk_mul_f32 v[116:117], v[196:197], v[46:47] op_sel:[0,1] op_sel_hi:[1,1]
    v_pk_mul_f32 v[118:119], v[198:199], v[46:47] op_sel:[0,1] op_sel_hi:[1,1]
    v_exp_f32 v112, v112
    v_exp_f32 v113, v113
    v_exp_f32 v114, v114
    v_exp_f32 v115, v115
    v_exp_f32 v116, v116
    v_exp_f32 v117, v117
    v_exp_f32 v118, v118
    v_exp_f32 v119, v119
    v_pk_mul_f32 v[200:201], v[192:193], v[200:201]
    v_pk_mul_f32 v[202:203], v[194:195], v[202:203]
    v_pk_mul_f32 v[204:205], v[196:197], v[204:205]
    v_pk_mul_f32 v[206:207], v[198:199], v[206:207]
    v_pk_fma_f32 v[112:113], v[112:113], v[48:49], v[48:49] op_sel_hi:[1,0,0]
    v_pk_fma_f32 v[114:115], v[114:115], v[48:49], v[48:49] op_sel_hi:[1,0,0]
    v_pk_fma_f32 v[116:117], v[116:117], v[48:49], v[48:49] op_sel_hi:[1,0,0]
    buffer_load_dword v40, v39, s[84:87], 0 offen sc1
    v_pk_fma_f32 v[118:119], v[118:119], v[48:49], v[48:49] op_sel_hi:[1,0,0]
    v_rcp_f32 v112, v112
    v_rcp_f32 v113, v113
    v_rcp_f32 v114, v114
    v_rcp_f32 v115, v115
    v_rcp_f32 v116, v116
    s_add_u32 m0, s89, 4096
    s_mul_i32 s92, s40, 14
    s_add_u32 s92, s92, 57344
    buffer_load_dwordx4 v33, s[72:75], s92 offen offset:0 lds
    v_rcp_f32 v117, v117
    v_rcp_f32 v118, v118
    v_rcp_f32_e64 v119, v119
    v_pk_mul_f32 v[200:201], v[200:201], v[112:113]
    v_pk_mul_f32 v[202:203], v[202:203], v[114:115]
    v_pk_mul_f32 v[204:205], v[204:205], v[116:117]
    v_pk_mul_f32 v[206:207], v[206:207], v[118:119]
    v_cvt_pk_bf16_f32 v96, v200, v201
    v_cvt_pk_bf16_f32 v97, v202, v203
    v_cvt_pk_bf16_f32 v98, v204, v205
    v_cvt_pk_bf16_f32 v99, v206, v207
    v_pk_mul_f32 v[120:121], v[208:209], v[46:47] op_sel:[0,1] op_sel_hi:[1,1]
    buffer_store_dwordx4 v[96:99], v32, s[84:87], s96 offen sc1
    v_pk_mul_f32 v[122:123], v[210:211], v[46:47] op_sel:[0,1] op_sel_hi:[1,1]
    v_pk_mul_f32 v[124:125], v[212:213], v[46:47] op_sel:[0,1] op_sel_hi:[1,1]
    v_pk_mul_f32 v[126:127], v[214:215], v[46:47] op_sel:[0,1] op_sel_hi:[1,1]
    v_exp_f32 v120, v120
    v_exp_f32 v121, v121
    v_exp_f32 v122, v122
    v_exp_f32 v123, v123
    v_exp_f32 v124, v124
    v_exp_f32 v125, v125
    v_exp_f32 v126, v126
    v_exp_f32 v127, v127
    v_pk_mul_f32 v[216:217], v[208:209], v[216:217]
    v_pk_mul_f32 v[218:219], v[210:211], v[218:219]
    v_pk_mul_f32 v[220:221], v[212:213], v[220:221]
    v_pk_mul_f32 v[222:223], v[214:215], v[222:223]
    v_pk_fma_f32 v[120:121], v[120:121], v[48:49], v[48:49] op_sel_hi:[1,0,0]
    buffer_load_dwordx4 v34, s[72:75], s92 offen offset:1024 lds
    v_pk_fma_f32 v[122:123], v[122:123], v[48:49], v[48:49] op_sel_hi:[1,0,0]
    v_pk_fma_f32 v[124:125], v[124:125], v[48:49], v[48:49] op_sel_hi:[1,0,0]
    v_pk_fma_f32 v[126:127], v[126:127], v[48:49], v[48:49] op_sel_hi:[1,0,0]
    v_rcp_f32 v120, v120
    v_rcp_f32 v121, v121
    v_rcp_f32 v122, v122
    v_rcp_f32 v123, v123
    v_rcp_f32 v124, v124
    v_rcp_f32 v125, v125
    v_rcp_f32 v126, v126
    v_rcp_f32 v127, v127
    v_pk_mul_f32 v[216:217], v[216:217], v[120:121]
    v_pk_mul_f32 v[218:219], v[218:219], v[122:123]
    v_pk_mul_f32 v[220:221], v[220:221], v[124:125]
    v_pk_mul_f32 v[222:223], v[222:223], v[126:127]
    v_cvt_pk_bf16_f32 v100, v216, v217
    v_cvt_pk_bf16_f32 v101, v218, v219
    v_cvt_pk_bf16_f32 v102, v220, v221
    v_cvt_pk_bf16_f32 v103, v222, v223
    v_pk_mul_f32 v[112:113], v[224:225], v[46:47] op_sel:[0,1] op_sel_hi:[1,1]
    buffer_store_dwordx4 v[100:103], v32, s[84:87], s97 offen sc1
    v_pk_mul_f32 v[114:115], v[226:227], v[46:47] op_sel:[0,1] op_sel_hi:[1,1]
    v_pk_mul_f32 v[116:117], v[228:229], v[46:47] op_sel:[0,1] op_sel_hi:[1,1]
    v_pk_mul_f32 v[118:119], v[230:231], v[46:47] op_sel:[0,1] op_sel_hi:[1,1]
    v_exp_f32 v112, v112
    v_exp_f32 v113, v113
    v_exp_f32 v114, v114
    v_exp_f32 v115, v115
    v_exp_f32 v116, v116
    v_exp_f32 v117, v117
    buffer_load_dwordx4 v26, s[72:75], s92 offen offset:2048 lds
    v_exp_f32 v118, v118
    v_exp_f32 v119, v119
    v_pk_mul_f32 v[232:233], v[224:225], v[232:233]
    v_pk_mul_f32 v[234:235], v[226:227], v[234:235]
    v_pk_mul_f32 v[236:237], v[228:229], v[236:237]
    v_pk_mul_f32 v[238:239], v[230:231], v[238:239]
    v_pk_fma_f32 v[112:113], v[112:113], v[48:49], v[48:49] op_sel_hi:[1,0,0]
    v_pk_fma_f32 v[114:115], v[114:115], v[48:49], v[48:49] op_sel_hi:[1,0,0]
    v_pk_fma_f32 v[116:117], v[116:117], v[48:49], v[48:49] op_sel_hi:[1,0,0]
    v_pk_fma_f32 v[118:119], v[118:119], v[48:49], v[48:49] op_sel_hi:[1,0,0]
    v_rcp_f32 v112, v112
    v_rcp_f32 v113, v113
    v_rcp_f32 v114, v114
    v_rcp_f32 v115, v115
    v_rcp_f32 v116, v116
    v_rcp_f32 v117, v117
    v_rcp_f32 v118, v118
    v_rcp_f32 v119, v119
    v_pk_mul_f32 v[232:233], v[232:233], v[112:113]
    v_pk_mul_f32 v[234:235], v[234:235], v[114:115]
    v_pk_mul_f32 v[236:237], v[236:237], v[116:117]
    v_pk_mul_f32 v[238:239], v[238:239], v[118:119]
    v_cvt_pk_bf16_f32 v104, v232, v233
    v_cvt_pk_bf16_f32 v105, v234, v235
    v_cvt_pk_bf16_f32 v106, v236, v237
    v_cvt_pk_bf16_f32 v107, v238, v239
    v_pk_mul_f32 v[120:121], v[240:241], v[46:47] op_sel:[0,1] op_sel_hi:[1,1]
    buffer_store_dwordx4 v[104:107], v32, s[84:87], s98 offen sc1
    v_pk_mul_f32 v[122:123], v[242:243], v[46:47] op_sel:[0,1] op_sel_hi:[1,1]
    buffer_load_dwordx4 v27, s[72:75], s92 offen offset:3072 lds
    v_pk_mul_f32 v[124:125], v[244:245], v[46:47] op_sel:[0,1] op_sel_hi:[1,1]
    v_pk_mul_f32 v[126:127], v[246:247], v[46:47] op_sel:[0,1] op_sel_hi:[1,1]
    v_exp_f32 v120, v120
    v_exp_f32 v121, v121
    v_exp_f32 v122, v122
    v_exp_f32 v123, v123
    v_exp_f32 v124, v124
    v_exp_f32 v125, v125
    v_exp_f32 v126, v126
    v_exp_f32 v127, v127
    v_pk_mul_f32 v[248:249], v[240:241], v[248:249]
    v_pk_mul_f32 v[250:251], v[242:243], v[250:251]
    v_pk_mul_f32 v[252:253], v[244:245], v[252:253]
    v_pk_mul_f32 v[254:255], v[246:247], v[254:255]
    v_pk_fma_f32 v[120:121], v[120:121], v[48:49], v[48:49] op_sel_hi:[1,0,0]
    v_pk_fma_f32 v[122:123], v[122:123], v[48:49], v[48:49] op_sel_hi:[1,0,0]
    v_pk_fma_f32 v[124:125], v[124:125], v[48:49], v[48:49] op_sel_hi:[1,0,0]
    v_pk_fma_f32 v[126:127], v[126:127], v[48:49], v[48:49] op_sel_hi:[1,0,0]
    v_rcp_f32 v120, v120
    v_rcp_f32 v121, v121
    v_rcp_f32_e64 v122, v122
    ds_read_b128 v[168:171], v50 offset:1216
    v_rcp_f32 v123, v123
    v_rcp_f32 v124, v124
    ds_read_b64_tr_b16 v[136:137], v49 offset:1032
    v_rcp_f32 v125, v125
    v_rcp_f32 v126, v126
    ds_read_b64_tr_b16 v[138:139], v49 offset:1024
    v_rcp_f32_e64 v127, v127
    v_pk_mul_f32 v[248:249], v[248:249], v[120:121]
    ds_read_b128 v[172:175], v50 offset:1728
    v_pk_mul_f32 v[250:251], v[250:251], v[122:123]
    v_pk_mul_f32 v[252:253], v[252:253], v[124:125]
    ds_read_b64_tr_b16 v[140:141], v49 offset:1544
    v_pk_mul_f32 v[254:255], v[254:255], v[126:127]
    v_cvt_pk_bf16_f32 v108, v248, v249
    ds_read_b64_tr_b16 v[142:143], v49 offset:1536
    v_cvt_pk_bf16_f32 v109, v250, v251
    v_cvt_pk_bf16_f32 v110, v252, v253
    v_cvt_pk_bf16_f32 v111, v254, v255
    buffer_store_dwordx4 v[108:111], v32, s[84:87], s99 offen sc1
    s_waitcnt lgkmcnt(6)
    v_mfma_f32_16x16x32_bf16 v[56:59], v[128:131], v[160:163], 0
    s_waitcnt vmcnt(8)
    v_cmp_gt_u32_e64 vcc, 2, v40
    s_mov_b32 s95, 0
    s_cbranch_vccnz Lslow2
Lback2:
    ds_read_b128 v[176:179], v50 offset:2240
    ds_read_b64_tr_b16 v[144:145], v49 offset:2056
    v_mfma_f32_16x16x32_bf16 v[60:63], v[128:131], v[164:167], 0
    ds_read_b64_tr_b16 v[146:147], v49 offset:2048
    ds_read_b128 v[180:183], v50 offset:2752
    v_mfma_f32_16x16x32_bf16 v[60:63], v[132:135], v[160:163], v[60:63]
    ds_read_b64_tr_b16 v[148:149], v49 offset:2568
    ds_read_b64_tr_b16 v[150:151], v49 offset:2560
    s_waitcnt lgkmcnt(6)
    s_nop 0
    v_mfma_f32_16x16x32_bf16 v[64:67], v[128:131], v[168:171], 0
    ds_read_b128 v[184:187], v50 offset:3264
    v_mfma_f32_16x16x32_bf16 v[64:67], v[132:135], v[164:167], v[64:67]
    ds_read_b64_tr_b16 v[152:153], v49 offset:3080
    ds_read_b64_tr_b16 v[154:155], v49 offset:3072
    v_mfma_f32_16x16x32_bf16 v[64:67], v[136:139], v[160:163], v[64:67]
    ds_read_b128 v[188:191], v50 offset:3776
    ds_read_b64_tr_b16 v[156:157], v49 offset:3592
    v_mfma_f32_16x16x32_bf16 v[68:71], v[128:131], v[172:175], 0
    ds_read_b64_tr_b16 v[158:159], v49 offset:3584
    v_mfma_f32_16x16x32_bf16 v[68:71], v[132:135], v[168:171], v[68:71]
    v_mfma_f32_16x16x32_bf16 v[68:71], v[136:139], v[164:167], v[68:71]
    ds_read_b128 v[224:227], v50 offset:128
    v_mfma_f32_16x16x32_bf16 v[68:71], v[140:143], v[160:163], v[68:71]
    ds_read_b64_tr_b16 v[192:193], v49 offset:72
    s_waitcnt lgkmcnt(8)
    s_nop 0
    v_mfma_f32_16x16x32_bf16 v[72:75], v[128:131], v[176:179], 0
    ds_read_b64_tr_b16 v[194:195], v49 offset:64
    v_mfma_f32_16x16x32_bf16 v[72:75], v[132:135], v[172:175], v[72:75]
    ds_read_b128 v[228:231], v50 offset:640
    v_mfma_f32_16x16x32_bf16 v[72:75], v[136:139], v[168:171], v[72:75]
    ds_read_b64_tr_b16 v[196:197], v49 offset:584
    v_mfma_f32_16x16x32_bf16 v[72:75], v[140:143], v[164:167], v[72:75]
    ds_read_b64_tr_b16 v[198:199], v49 offset:576
    v_mfma_f32_16x16x32_bf16 v[72:75], v[144:147], v[160:163], v[72:75]
    ds_read_b128 v[232:235], v50 offset:1152
    v_mfma_f32_16x16x32_bf16 v[76:79], v[128:131], v[180:183], 0
    ds_read_b64_tr_b16 v[200:201], v49 offset:1096
    v_mfma_f32_16x16x32_bf16 v[76:79], v[132:135], v[176:179], v[76:79]
    ds_read_b64_tr_b16 v[202:203], v49 offset:1088
    v_mfma_f32_16x16x32_bf16 v[76:79], v[136:139], v[172:175], v[76:79]
    ds_read_b128 v[236:239], v50 offset:1664
    buffer_load_dwordx4 a[0:3], v28, s[84:87], s28 offen sc1
    v_mfma_f32_16x16x32_bf16 v[76:79], v[140:143], v[168:171], v[76:79]
    ds_read_b64_tr_b16 v[204:205], v49 offset:1608
    v_mfma_f32_16x16x32_bf16 v[76:79], v[144:147], v[164:167], v[76:79]
    ds_read_b64_tr_b16 v[206:207], v49 offset:1600
    v_mfma_f32_16x16x32_bf16 v[76:79], v[148:151], v[160:163], v[76:79]
    s_waitcnt lgkmcnt(12)
    s_nop 0
    v_mfma_f32_16x16x32_bf16 v[80:83], v[128:131], v[184:187], 0
    ds_read_b128 v[240:243], v50 offset:2176
    buffer_load_dwordx4 a[4:7], v29, s[84:87], s28 offen sc1
    v_mfma_f32_16x16x32_bf16 v[80:83], v[132:135], v[180:183], v[80:83]
    ds_read_b64_tr_b16 v[208:209], v49 offset:2120
    v_mfma_f32_16x16x32_bf16 v[80:83], v[136:139], v[176:179], v[80:83]
    ds_read_b64_tr_b16 v[210:211], v49 offset:2112
    v_mfma_f32_16x16x32_bf16 v[80:83], v[140:143], v[172:175], v[80:83]
    ds_read_b128 v[244:247], v50 offset:2688
    v_mfma_f32_16x16x32_bf16 v[80:83], v[144:147], v[168:171], v[80:83]
    ds_read_b64_tr_b16 v[212:213], v49 offset:2632
    buffer_load_dwordx4 a[8:11], v28, s[84:87], s29 offen sc1
    v_mfma_f32_16x16x32_bf16 v[80:83], v[148:151], v[164:167], v[80:83]
    ds_read_b64_tr_b16 v[214:215], v49 offset:2624
    v_mfma_f32_16x16x32_bf16 v[80:83], v[152:155], v[160:163], v[80:83]
    ds_read_b128 v[248:251], v50 offset:3200
    v_mfma_f32_16x16x32_bf16 v[84:87], v[128:131], v[188:191], 0
    ds_read_b64_tr_b16 v[216:217], v49 offset:3144
    v_mfma_f32_16x16x32_bf16 v[84:87], v[132:135], v[184:187], v[84:87]
    ds_read_b64_tr_b16 v[218:219], v49 offset:3136
    buffer_load_dwordx4 a[12:15], v29, s[84:87], s29 offen sc1
    v_mfma_f32_16x16x32_bf16 v[84:87], v[136:139], v[180:183], v[84:87]
    ds_read_b128 v[252:255], v50 offset:3712
    v_mfma_f32_16x16x32_bf16 v[84:87], v[140:143], v[176:179], v[84:87]
    ds_read_b64_tr_b16 v[220:221], v49 offset:3656
    v_mfma_f32_16x16x32_bf16 v[84:87], v[144:147], v[172:175], v[84:87]
    ds_read_b64_tr_b16 v[222:223], v49 offset:3648
    v_mfma_f32_16x16x32_bf16 v[84:87], v[148:151], v[168:171], v[84:87]
    buffer_load_dwordx4 a[16:19], v28, s[84:87], s30 offen sc1
    v_mfma_f32_16x16x32_bf16 v[84:87], v[152:155], v[164:167], v[84:87]
    v_mfma_f32_16x16x32_bf16 v[84:87], v[156:159], v[160:163], v[84:87]
    s_waitcnt lgkmcnt(12)
    s_nop 0
    v_mfma_f32_16x16x32_bf16 v[56:59], v[192:195], v[224:227], v[56:59]
    ds_read_b128 v[160:163], v50 offset:64
    v_mfma_f32_16x16x32_bf16 v[60:63], v[192:195], v[228:231], v[60:63]
    buffer_load_dwordx4 a[20:23], v29, s[84:87], s30 offen sc1
    v_mfma_f32_16x16x32_bf16 v[60:63], v[196:199], v[224:227], v[60:63]
    ds_read_b64_tr_b16 v[128:129], v49 offset:136
    v_mfma_f32_16x16x32_bf16 v[64:67], v[192:195], v[232:235], v[64:67]
    ds_read_b64_tr_b16 v[130:131], v49 offset:128
    v_mfma_f32_16x16x32_bf16 v[64:67], v[196:199], v[228:231], v[64:67]
    ds_read_b128 v[164:167], v50 offset:576
    v_mfma_f32_16x16x32_bf16 v[64:67], v[200:203], v[224:227], v[64:67]
    buffer_load_dwordx4 a[24:27], v28, s[84:87], s31 offen sc1
    v_mfma_f32_16x16x32_bf16 v[68:71], v[192:195], v[236:239], v[68:71]
    ds_read_b64_tr_b16 v[132:133], v49 offset:648
    v_mfma_f32_16x16x32_bf16 v[68:71], v[196:199], v[232:235], v[68:71]
    ds_read_b64_tr_b16 v[134:135], v49 offset:640
    v_mfma_f32_16x16x32_bf16 v[68:71], v[200:203], v[228:231], v[68:71]
    ds_read_b128 v[168:171], v50 offset:1088
    s_waitcnt vmcnt(7)
    s_barrier
    v_mov_b32 v2, 3
    buffer_store_dword v2, v0, s[84:87], 0 offen sc1
    v_mfma_f32_16x16x32_bf16 v[68:71], v[204:207], v[224:227], v[68:71]
    buffer_load_dwordx4 a[28:31], v29, s[84:87], s31 offen sc1
    s_waitcnt lgkmcnt(7)
    v_mfma_f32_16x16x32_bf16 v[72:75], v[192:195], v[240:243], v[72:75]
    ds_read_b64_tr_b16 v[136:137], v49 offset:1160
    v_mfma_f32_16x16x32_bf16 v[72:75], v[196:199], v[236:239], v[72:75]
    ds_read_b64_tr_b16 v[138:139], v49 offset:1152
    v_mfma_f32_16x16x32_bf16 v[72:75], v[200:203], v[232:235], v[72:75]
    ds_read_b128 v[172:175], v50 offset:1600
    v_mfma_f32_16x16x32_bf16 v[72:75], v[204:207], v[228:231], v[72:75]
    buffer_load_dwordx4 a[32:35], v28, s[84:87], s32 offen sc1
    v_mfma_f32_16x16x32_bf16 v[72:75], v[208:211], v[224:227], v[72:75]
    ds_read_b64_tr_b16 v[140:141], v49 offset:1672
    v_mfma_f32_16x16x32_bf16 v[76:79], v[192:195], v[244:247], v[76:79]
    ds_read_b64_tr_b16 v[142:143], v49 offset:1664
    v_mfma_f32_16x16x32_bf16 v[76:79], v[196:199], v[240:243], v[76:79]
    ds_read_b128 v[176:179], v50 offset:2112
    v_mfma_f32_16x16x32_bf16 v[76:79], v[200:203], v[236:239], v[76:79]
    buffer_load_dwordx4 a[36:39], v29, s[84:87], s32 offen sc1
    v_mfma_f32_16x16x32_bf16 v[76:79], v[204:207], v[232:235], v[76:79]
    ds_read_b64_tr_b16 v[144:145], v49 offset:2184
    v_mfma_f32_16x16x32_bf16 v[76:79], v[208:211], v[228:231], v[76:79]
    ds_read_b64_tr_b16 v[146:147], v49 offset:2176
    v_mfma_f32_16x16x32_bf16 v[76:79], v[212:215], v[224:227], v[76:79]
    ds_read_b128 v[180:183], v50 offset:2624
    v_mfma_f32_16x16x32_bf16 v[80:83], v[192:195], v[248:251], v[80:83]
    buffer_load_dwordx4 a[40:43], v28, s[84:87], s33 offen sc1
    v_mfma_f32_16x16x32_bf16 v[80:83], v[196:199], v[244:247], v[80:83]
    ds_read_b64_tr_b16 v[148:149], v49 offset:2696
    v_mfma_f32_16x16x32_bf16 v[80:83], v[200:203], v[240:243], v[80:83]
    ds_read_b64_tr_b16 v[150:151], v49 offset:2688
    v_mfma_f32_16x16x32_bf16 v[80:83], v[204:207], v[236:239], v[80:83]
    ds_read_b128 v[184:187], v50 offset:3136
    v_mfma_f32_16x16x32_bf16 v[80:83], v[208:211], v[232:235], v[80:83]
    buffer_load_dwordx4 a[44:47], v29, s[84:87], s33 offen sc1
    v_mfma_f32_16x16x32_bf16 v[80:83], v[212:215], v[228:231], v[80:83]
    ds_read_b64_tr_b16 v[152:153], v49 offset:3208
    v_mfma_f32_16x16x32_bf16 v[80:83], v[216:219], v[224:227], v[80:83]
    ds_read_b64_tr_b16 v[154:155], v49 offset:3200
    v_mfma_f32_16x16x32_bf16 v[84:87], v[192:195], v[252:255], v[84:87]
    ds_read_b128 v[188:191], v50 offset:3648
    v_mfma_f32_16x16x32_bf16 v[84:87], v[196:199], v[248:251], v[84:87]
    buffer_load_dwordx4 a[48:51], v28, s[84:87], s34 offen sc1
    v_mfma_f32_16x16x32_bf16 v[84:87], v[200:203], v[244:247], v[84:87]
    ds_read_b64_tr_b16 v[156:157], v49 offset:3720
    v_mfma_f32_16x16x32_bf16 v[84:87], v[204:207], v[240:243], v[84:87]
    ds_read_b64_tr_b16 v[158:159], v49 offset:3712
    v_mfma_f32_16x16x32_bf16 v[84:87], v[208:211], v[236:239], v[84:87]
    v_mfma_f32_16x16x32_bf16 v[84:87], v[212:215], v[232:235], v[84:87]
    buffer_load_dwordx4 a[52:55], v29, s[84:87], s34 offen sc1
    v_mfma_f32_16x16x32_bf16 v[84:87], v[216:219], v[228:231], v[84:87]
    v_mfma_f32_16x16x32_bf16 v[84:87], v[220:223], v[224:227], v[84:87]
    s_waitcnt lgkmcnt(12)
    s_nop 0
    v_mfma_f32_16x16x32_bf16 v[56:59], v[128:131], v[160:163], v[56:59]
    ds_read_b128 v[224:227], v50 offset:0
    v_mfma_f32_16x16x32_bf16 v[60:63], v[128:131], v[164:167], v[60:63]
    buffer_load_dwordx4 a[56:59], v28, s[84:87], s35 offen sc1
    v_mfma_f32_16x16x32_bf16 v[60:63], v[132:135], v[160:163], v[60:63]
    ds_read_b64_tr_b16 v[192:193], v49 offset:200
    v_mfma_f32_16x16x32_bf16 v[64:67], v[128:131], v[168:171], v[64:67]
    ds_read_b64_tr_b16 v[194:195], v49 offset:192
    v_mfma_f32_16x16x32_bf16 v[64:67], v[132:135], v[164:167], v[64:67]
    ds_read_b128 v[228:231], v50 offset:512
    v_mfma_f32_16x16x32_bf16 v[64:67], v[136:139], v[160:163], v[64:67]
    buffer_load_dwordx4 a[60:63], v29, s[84:87], s35 offen sc1
    v_mfma_f32_16x16x32_bf16 v[68:71], v[128:131], v[172:175], v[68:71]
    ds_read_b64_tr_b16 v[196:197], v49 offset:712
    v_mfma_f32_16x16x32_bf16 v[68:71], v[132:135], v[168:171], v[68:71]
    ds_read_b64_tr_b16 v[198:199], v49 offset:704
    v_mfma_f32_16x16x32_bf16 v[68:71], v[136:139], v[164:167], v[68:71]
    ds_read_b128 v[232:235], v50 offset:1024
    v_mfma_f32_16x16x32_bf16 v[68:71], v[140:143], v[160:163], v[68:71]
    buffer_load_dwordx4 a[64:67], v28, s[84:87], s36 offen sc1
    s_waitcnt lgkmcnt(7)
    s_nop 0
    v_mfma_f32_16x16x32_bf16 v[72:75], v[128:131], v[176:179], v[72:75]
    ds_read_b64_tr_b16 v[200:201], v49 offset:1224
    v_mfma_f32_16x16x32_bf16 v[72:75], v[132:135], v[172:175], v[72:75]
    ds_read_b64_tr_b16 v[202:203], v49 offset:1216
    v_mfma_f32_16x16x32_bf16 v[72:75], v[136:139], v[168:171], v[72:75]
    ds_read_b128 v[236:239], v50 offset:1536
    v_mfma_f32_16x16x32_bf16 v[72:75], v[140:143], v[164:167], v[72:75]
    buffer_load_dwordx4 a[68:71], v29, s[84:87], s36 offen sc1
    v_mfma_f32_16x16x32_bf16 v[72:75], v[144:147], v[160:163], v[72:75]
    ds_read_b64_tr_b16 v[204:205], v49 offset:1736
    v_mfma_f32_16x16x32_bf16 v[76:79], v[128:131], v[180:183], v[76:79]
    ds_read_b64_tr_b16 v[206:207], v49 offset:1728
    v_mfma_f32_16x16x32_bf16 v[76:79], v[132:135], v[176:179], v[76:79]
    ds_read_b128 v[240:243], v50 offset:2048
    v_mfma_f32_16x16x32_bf16 v[76:79], v[136:139], v[172:175], v[76:79]
    buffer_load_dwordx4 a[72:75], v28, s[84:87], s37 offen sc1
    v_mfma_f32_16x16x32_bf16 v[76:79], v[140:143], v[168:171], v[76:79]
    ds_read_b64_tr_b16 v[208:209], v49 offset:2248
    v_mfma_f32_16x16x32_bf16 v[76:79], v[144:147], v[164:167], v[76:79]
    ds_read_b64_tr_b16 v[210:211], v49 offset:2240
    v_mfma_f32_16x16x32_bf16 v[76:79], v[148:151], v[160:163], v[76:79]
    ds_read_b128 v[244:247], v50 offset:2560
    v_mfma_f32_16x16x32_bf16 v[80:83], v[128:131], v[184:187], v[80:83]
    buffer_load_dwordx4 a[76:79], v29, s[84:87], s37 offen sc1
    v_mfma_f32_16x16x32_bf16 v[80:83], v[132:135], v[180:183], v[80:83]
    ds_read_b64_tr_b16 v[212:213], v49 offset:2760
    v_mfma_f32_16x16x32_bf16 v[80:83], v[136:139], v[176:179], v[80:83]
    ds_read_b64_tr_b16 v[214:215], v49 offset:2752
    v_mfma_f32_16x16x32_bf16 v[80:83], v[140:143], v[172:175], v[80:83]
    ds_read_b128 v[248:251], v50 offset:3072
    v_mfma_f32_16x16x32_bf16 v[80:83], v[144:147], v[168:171], v[80:83]
    buffer_load_dwordx4 a[80:83], v28, s[84:87], s38 offen sc1
    v_mfma_f32_16x16x32_bf16 v[80:83], v[148:151], v[164:167], v[80:83]
    ds_read_b64_tr_b16 v[216:217], v49 offset:3272
    v_mfma_f32_16x16x32_bf16 v[80:83], v[152:155], v[160:163], v[80:83]
    ds_read_b64_tr_b16 v[218:219], v49 offset:3264
    v_mfma_f32_16x16x32_bf16 v[84:87], v[128:131], v[188:191], v[84:87]
    ds_read_b128 v[252:255], v50 offset:3584
    v_mfma_f32_16x16x32_bf16 v[84:87], v[132:135], v[184:187], v[84:87]
    buffer_load_dwordx4 a[84:87], v29, s[84:87], s38 offen sc1
    v_mfma_f32_16x16x32_bf16 v[84:87], v[136:139], v[180:183], v[84:87]
    ds_read_b64_tr_b16 v[220:221], v49 offset:3784
    v_mfma_f32_16x16x32_bf16 v[84:87], v[140:143], v[176:179], v[84:87]
    ds_read_b64_tr_b16 v[222:223], v49 offset:3776
    v_mfma_f32_16x16x32_bf16 v[84:87], v[144:147], v[172:175], v[84:87]
    v_mfma_f32_16x16x32_bf16 v[84:87], v[148:151], v[168:171], v[84:87]
    buffer_load_dwordx4 a[88:91], v28, s[84:87], s39 offen sc1
    v_mfma_f32_16x16x32_bf16 v[84:87], v[152:155], v[164:167], v[84:87]
    v_mfma_f32_16x16x32_bf16 v[84:87], v[156:159], v[160:163], v[84:87]
    s_waitcnt lgkmcnt(12)
    s_nop 0
    v_mfma_f32_16x16x32_bf16 v[56:59], v[192:195], v[224:227], v[56:59]
    s_waitcnt lgkmcnt(0)
    s_barrier
    v_mfma_f32_16x16x32_bf16 v[60:63], v[192:195], v[228:231], v[60:63]
    buffer_load_dwordx4 a[92:95], v29, s[84:87], s39 offen sc1
    v_mfma_f32_16x16x32_bf16 v[60:63], v[196:199], v[224:227], v[60:63]
    v_mfma_f32_16x16x32_bf16 v[64:67], v[192:195], v[232:235], v[64:67]
    v_mfma_f32_16x16x32_bf16 v[64:67], v[196:199], v[228:231], v[64:67]
    v_mfma_f32_16x16x32_bf16 v[64:67], v[200:203], v[224:227], v[64:67]
    buffer_load_dwordx4 a[96:99], v28, s[84:87], s40 offen sc1
    v_mfma_f32_16x16x32_bf16 v[68:71], v[192:195], v[236:239], v[68:71]
    v_mfma_f32_16x16x32_bf16 v[68:71], v[196:199], v[232:235], v[68:71]
    v_mfma_f32_16x16x32_bf16 v[68:71], v[200:203], v[228:231], v[68:71]
    buffer_load_dword v40, v38, s[84:87], 0 offen sc1
    v_mfma_f32_16x16x32_bf16 v[68:71], v[204:207], v[224:227], v[68:71]
    buffer_load_dwordx4 a[100:103], v29, s[84:87], s40 offen sc1
    v_mfma_f32_16x16x32_bf16 v[72:75], v[192:195], v[240:243], v[72:75]
    v_mfma_f32_16x16x32_bf16 v[72:75], v[196:199], v[236:239], v[72:75]
    v_mfma_f32_16x16x32_bf16 v[72:75], v[200:203], v[232:235], v[72:75]
    v_mfma_f32_16x16x32_bf16 v[72:75], v[204:207], v[228:231], v[72:75]
    buffer_load_dwordx4 a[104:107], v28, s[84:87], s41 offen sc1
    v_mfma_f32_16x16x32_bf16 v[72:75], v[208:211], v[224:227], v[72:75]
    ds_write_b128 v8, v[56:59] offset:0
    v_mfma_f32_16x16x32_bf16 v[76:79], v[192:195], v[244:247], v[76:79]
    v_mfma_f32_16x16x32_bf16 v[76:79], v[196:199], v[240:243], v[76:79]
    v_mfma_f32_16x16x32_bf16 v[76:79], v[200:203], v[236:239], v[76:79]
    buffer_load_dwordx4 a[108:111], v29, s[84:87], s41 offen sc1
    v_mfma_f32_16x16x32_bf16 v[76:79], v[204:207], v[232:235], v[76:79]
    ds_write_b128 v8, v[60:63] offset:1024
    v_mfma_f32_16x16x32_bf16 v[76:79], v[208:211], v[228:231], v[76:79]
    v_mfma_f32_16x16x32_bf16 v[76:79], v[212:215], v[224:227], v[76:79]
    v_mfma_f32_16x16x32_bf16 v[80:83], v[192:195], v[248:251], v[80:83]
    v_mfma_f32_16x16x32_bf16 v[80:83], v[196:199], v[244:247], v[80:83]
    ds_write_b128 v8, v[64:67] offset:2048
    v_mfma_f32_16x16x32_bf16 v[80:83], v[200:203], v[240:243], v[80:83]
    v_mfma_f32_16x16x32_bf16 v[80:83], v[204:207], v[236:239], v[80:83]
    v_mfma_f32_16x16x32_bf16 v[80:83], v[208:211], v[232:235], v[80:83]
    v_mfma_f32_16x16x32_bf16 v[80:83], v[212:215], v[228:231], v[80:83]
    ds_write_b128 v8, v[68:71] offset:3072
    v_mfma_f32_16x16x32_bf16 v[80:83], v[216:219], v[224:227], v[80:83]
    v_mfma_f32_16x16x32_bf16 v[84:87], v[192:195], v[252:255], v[84:87]
    v_mfma_f32_16x16x32_bf16 v[84:87], v[196:199], v[248:251], v[84:87]
    v_mfma_f32_16x16x32_bf16 v[84:87], v[200:203], v[244:247], v[84:87]
    ds_write_b128 v8, v[72:75] offset:4096
    v_mfma_f32_16x16x32_bf16 v[84:87], v[204:207], v[240:243], v[84:87]
    v_mfma_f32_16x16x32_bf16 v[84:87], v[208:211], v[236:239], v[84:87]
    v_mfma_f32_16x16x32_bf16 v[84:87], v[212:215], v[232:235], v[84:87]
    v_mfma_f32_16x16x32_bf16 v[84:87], v[216:219], v[228:231], v[84:87]
    v_mfma_f32_16x16x32_bf16 v[84:87], v[220:223], v[224:227], v[84:87]
    s_waitcnt vmcnt(29)
    s_nop 0
    v_mfma_f32_32x32x16_bf16 v[128:143], a[112:115], a[0:3], 0
    ds_write_b128 v8, v[76:79] offset:5120
    v_mfma_f32_32x32x16_bf16 v[144:159], a[116:119], a[0:3], 0
    s_waitcnt vmcnt(28)
    v_mfma_f32_32x32x16_bf16 v[160:175], a[112:115], a[4:7], 0
    ds_write_b128 v8, v[80:83] offset:6144
    v_mfma_f32_32x32x16_bf16 v[176:191], a[116:119], a[4:7], 0
    s_waitcnt vmcnt(27)
    v_mfma_f32_32x32x16_bf16 v[128:143], a[120:123], a[8:11], v[128:143]
    ds_write_b128 v8, v[84:87] offset:7168
    v_mfma_f32_32x32x16_bf16 v[144:159], a[124:127], a[8:11], v[144:159]
    ds_read_b64 v[88:89], v7 offset:0
    ds_read_b64 v[90:91], v7 offset:4608
    ds_read_b64 v[92:93], v7 offset:512
    ds_read_b64 v[94:95], v7 offset:5120
    s_waitcnt vmcnt(26)
    v_mfma_f32_32x32x16_bf16 v[160:175], a[120:123], a[12:15], v[160:175]
    v_mfma_f32_32x32x16_bf16 v[176:191], a[124:127], a[12:15], v[176:191]
    s_waitcnt lgkmcnt(0)
    s_barrier
    ds_read_b128 v[56:59], v3 offset:0
    ds_read_b128 v[60:63], v3 offset:8192
    ds_read_b128 v[64:67], v3 offset:16384
    s_waitcnt vmcnt(25)
    v_mfma_f32_32x32x16_bf16 v[128:143], a[128:131], a[16:19], v[128:143]
    ds_read_b128 v[68:71], v3 offset:24576
    ds_read_b128 v[72:75], v3 offset:1024
    ds_read_b128 v[76:79], v3 offset:9216
    s_waitcnt vmcnt(3)
    v_cmp_gt_u32 vcc, v37, v40
    s_mov_b32 s95, 0
    s_cbranch_vccnz Lslow3
Lback3:
    v_mfma_f32_32x32x16_bf16 v[144:159], a[132:135], a[16:19], v[144:159]
    ds_read_b128 v[80:83], v3 offset:17408
    ds_read_b128 v[84:87], v3 offset:25600
    buffer_load_dwordx4 a[224:227], v30, s[84:87], s28 offen sc1
    v_mfma_f32_32x32x16_bf16 v[160:175], a[128:131], a[20:23], v[160:175]
    v_mfma_f32_32x32x16_bf16 v[176:191], a[132:135], a[20:23], v[176:191]
    s_waitcnt lgkmcnt(4)
    v_add_f32 v56, v56, v60
    v_add_f32 v57, v57, v61
    v_add_f32 v58, v58, v62
    v_add_f32_e64 v59, v59, v63
    buffer_load_dwordx4 a[228:231], v30, s[84:87], s29 offen sc1
    v_mfma_f32_32x32x16_bf16 v[128:143], a[136:139], a[24:27], v[128:143]
    v_lshlrev_b32_e64 v60, 16, v88
    v_and_b32 v61, 0xffff0000, v88
    v_lshlrev_b32_e64 v62, 16, v89
    v_and_b32 v63, 0xffff0000, v89
    v_mfma_f32_32x32x16_bf16 v[144:159], a[140:143], a[24:27], v[144:159]
    v_fmac_f32 v56, v9, v60
    v_fmac_f32 v57, v9, v61
    v_fmac_f32_e64 v58, v9, v62
    v_mfma_f32_32x32x16_bf16 v[160:175], a[136:139], a[28:31], v[160:175]
    v_fmac_f32 v59, v9, v63
    v_add_f32 v64, v64, v68
    v_add_f32 v65, v65, v69
    v_add_f32 v66, v66, v70
    buffer_load_dwordx4 a[232:235], v30, s[84:87], s30 offen sc1
    v_mfma_f32_32x32x16_bf16 v[176:191], a[140:143], a[28:31], v[176:191]
    v_add_f32 v67, v67, v71
    v_lshlrev_b32 v68, 16, v90
    v_and_b32 v69, 0xffff0000, v90
    v_lshlrev_b32_e64 v70, 16, v91
    v_mfma_f32_32x32x16_bf16 v[128:143], a[144:147], a[32:35], v[128:143]
    v_and_b32 v71, 0xffff0000, v91
    v_fmac_f32 v64, v10, v68
    v_fmac_f32 v65, v10, v69
    buffer_load_dwordx4 a[236:239], v30, s[84:87], s31 offen sc1
    v_mfma_f32_32x32x16_bf16 v[144:159], a[148:151], a[32:35], v[144:159]
    v_fmac_f32 v66, v10, v70
    v_fmac_f32 v67, v10, v71
    v_cvt_pk_bf16_f32 v60, v56, v64
    v_cvt_pk_bf16_f32 v61, v57, v65
    v_mfma_f32_32x32x16_bf16 v[160:175], a[144:147], a[36:39], v[160:175]
    v_cvt_pk_bf16_f32 v62, v58, v66
    v_cvt_pk_bf16_f32 v63, v59, v67
    buffer_store_dwordx4 v[60:63], v32, s[84:87], s51 offen offset:0 sc1
    v_mfma_f32_32x32x16_bf16 v[176:191], a[148:151], a[36:39], v[176:191]
    s_waitcnt lgkmcnt(0)
    v_add_f32 v72, v72, v76
    v_add_f32 v73, v73, v77
    v_add_f32 v74, v74, v78
    v_add_f32_e64 v75, v75, v79
    buffer_load_dwordx4 a[240:243], v30, s[84:87], s32 offen sc1
    v_mfma_f32_32x32x16_bf16 v[128:143], a[152:155], a[40:43], v[128:143]
    v_lshlrev_b32_e64 v76, 16, v92
    v_and_b32 v77, 0xffff0000, v92
    v_lshlrev_b32_e64 v78, 16, v93
    v_and_b32 v79, 0xffff0000, v93
    ds_read_b64_tr_b16 a[0:1], v24 offset:32768
    ds_read_b64_tr_b16 a[2:3], v24 offset:33792
    v_mfma_f32_32x32x16_bf16 v[144:159], a[156:159], a[40:43], v[144:159]
    v_fmac_f32 v72, v9, v76
    v_fmac_f32 v73, v9, v77
    v_fmac_f32_e64 v74, v9, v78
    buffer_load_dwordx4 a[244:247], v30, s[84:87], s33 offen sc1
    ds_read_b64_tr_b16 a[4:5], v25 offset:32768
    v_mfma_f32_32x32x16_bf16 v[160:175], a[152:155], a[44:47], v[160:175]
    v_fmac_f32 v75, v9, v79
    v_add_f32 v80, v80, v84
    v_add_f32 v81, v81, v85
    v_add_f32 v82, v82, v86
    ds_read_b64_tr_b16 a[6:7], v25 offset:33792
    v_mfma_f32_32x32x16_bf16 v[176:191], a[156:159], a[44:47], v[176:191]
    v_add_f32 v83, v83, v87
    v_lshlrev_b32 v84, 16, v94
    v_and_b32 v85, 0xffff0000, v94
    v_lshlrev_b32_e64 v86, 16, v95
    ds_read_b64_tr_b16 a[8:9], v24 offset:34816
    ds_read_b64_tr_b16 a[10:11], v24 offset:35840
    v_mfma_f32_32x32x16_bf16 v[128:143], a[160:163], a[48:51], v[128:143]
    v_and_b32 v87, 0xffff0000, v95
    v_fmac_f32 v80, v10, v84
    v_fmac_f32 v81, v10, v85
    buffer_load_dwordx4 a[248:251], v30, s[84:87], s34 offen sc1
    ds_read_b64_tr_b16 a[12:13], v25 offset:34816
    v_mfma_f32_32x32x16_bf16 v[144:159], a[164:167], a[48:51], v[144:159]
    v_fmac_f32 v82, v10, v86
    v_fmac_f32 v83, v10, v87
    v_cvt_pk_bf16_f32 v76, v72, v80
    v_cvt_pk_bf16_f32 v77, v73, v81
    ds_read_b64_tr_b16 a[14:15], v25 offset:35840
    v_mfma_f32_32x32x16_bf16 v[160:175], a[160:163], a[52:55], v[160:175]
    v_cvt_pk_bf16_f32 v78, v74, v82
    v_cvt_pk_bf16_f32 v79, v75, v83
    buffer_store_dwordx4 v[76:79], v32, s[84:87], s51 offen offset:1024 sc1
    buffer_load_dwordx4 a[252:255], v30, s[84:87], s35 offen sc1
    ds_read_b64_tr_b16 a[16:17], v24 offset:49152
    ds_read_b64_tr_b16 a[18:19], v24 offset:50176
    v_mfma_f32_32x32x16_bf16 v[176:191], a[164:167], a[52:55], v[176:191]
    ds_read_b64_tr_b16 a[20:21], v25 offset:49152
    v_mfma_f32_32x32x16_bf16 v[128:143], a[168:171], a[56:59], v[128:143]
    ds_read_b64_tr_b16 a[22:23], v25 offset:50176
    v_lshrrev_b32 v5, 3, v1
    v_and_b32 v6, 7, v1
    v_mfma_f32_32x32x16_bf16 v[144:159], a[172:175], a[56:59], v[144:159]
    buffer_load_dwordx4 v[232:235], v30, s[84:87], s36 offen sc1
    ds_read_b64_tr_b16 a[24:25], v24 offset:51200
    ds_read_b64_tr_b16 a[26:27], v24 offset:52224
    v_mul_u32_u24 v8, 896, v5
    v_lshl_add_u32 v8, v6, 4, v8
    v_mfma_f32_32x32x16_bf16 v[160:175], a[168:171], a[60:63], v[160:175]
    ds_read_b64_tr_b16 a[28:29], v25 offset:51200
    s_lshl3_add_u32 s15, s6, s3
    s_nop 0
    s_mul_i32 s15, s15, 7168
    v_mfma_f32_32x32x16_bf16 v[176:191], a[172:175], a[60:63], v[176:191]
    buffer_load_dwordx4 v[236:239], v30, s[84:87], s37 offen sc1
    ds_read_b64_tr_b16 a[30:31], v25 offset:52224
    s_lshl_b32 s42, s5, 7
    s_add_u32 s93, s15, s42
    v_mfma_f32_32x32x16_bf16 v[128:143], a[176:179], a[64:67], v[128:143]
    ds_read_b64_tr_b16 a[32:33], v35 offset:8192
    ds_read_b64_tr_b16 a[34:35], v35 offset:9216
    s_add_u32 s94, s93, 28672
    v_mfma_f32_32x32x16_bf16 v[144:159], a[180:183], a[64:67], v[144:159]
    ds_read_b64_tr_b16 a[36:37], v36 offset:8192
    buffer_load_dwordx4 v[56:59], v8, s[44:47], s93 offen
    buffer_load_dwordx4 v[60:63], v8, s[44:47], s94 offen
    v_mfma_f32_32x32x16_bf16 v[160:175], a[176:179], a[68:71], v[160:175]
    buffer_load_dwordx4 v[240:243], v30, s[84:87], s38 offen sc1
    ds_read_b64_tr_b16 a[38:39], v36 offset:9216
    v_and_b32 v13, 15, v1
    s_lshl_b32 s15, s3, 1
    v_mfma_f32_32x32x16_bf16 v[176:191], a[180:183], a[68:71], v[176:191]
    ds_read_b64_tr_b16 a[40:41], v35 offset:10240
    ds_read_b64_tr_b16 a[42:43], v35 offset:11264
    v_xor_b32 v13, s15, v13
    v_lshlrev_b32 v13, 4, v13
    v_mfma_f32_32x32x16_bf16 v[128:143], a[184:187], a[72:75], v[128:143]
    buffer_load_dwordx4 v[244:247], v30, s[84:87], s39 offen sc1
    ds_read_b64_tr_b16 a[44:45], v36 offset:10240
    v_lshrrev_b32_e64 v3, 4, v1
    v_mfma_f32_32x32x16_bf16 v[144:159], a[188:191], a[72:75], v[144:159]
    ds_read_b64_tr_b16 a[46:47], v36 offset:11264
    v_lshl_add_u32 v3, v3, 13, v13
    v_xor_b32_e64 v4, 16, v3
    v_mfma_f32_32x32x16_bf16 v[160:175], a[184:187], a[76:79], v[160:175]
    ds_read_b64_tr_b16 a[48:49], v24 offset:0
    ds_read_b64_tr_b16 a[50:51], v24 offset:1024
    v_add_u32 v4, 32768, v4
    s_lshl2_add_u32 s15, s5, s3
    v_mfma_f32_32x32x16_bf16 v[176:191], a[188:191], a[76:79], v[176:191]
    buffer_load_dwordx4 v[248:251], v30, s[84:87], s40 offen sc1
    ds_read_b64_tr_b16 a[52:53], v25 offset:0
    s_lshl_b32 s15, s15, 16
    s_lshl_b32 s42, s6, 8
    v_mfma_f32_32x32x16_bf16 v[128:143], a[192:195], a[80:83], v[128:143]
    ds_read_b64_tr_b16 a[54:55], v25 offset:1024
    s_add_u32 s15, s15, s42
    s_add_u32 s92, s15, 2097152
    v_mfma_f32_32x32x16_bf16 v[144:159], a[196:199], a[80:83], v[144:159]
    buffer_load_dwordx4 v[252:255], v30, s[84:87], s41 offen sc1
    ds_read_b64_tr_b16 a[56:57], v24 offset:2048
    ds_read_b64_tr_b16 a[58:59], v24 offset:3072
    s_lshl_b32 s42, s3, 11
    v_mfma_f32_32x32x16_bf16 v[160:175], a[192:195], a[84:87], v[160:175]
    ds_read_b64_tr_b16 a[60:61], v25 offset:2048
    s_add_u32 s15, s42, 147968
    v_add_u32 v13, s15, v32
    v_mfma_f32_32x32x16_bf16 v[176:191], a[196:199], a[84:87], v[176:191]
    ds_read_b64_tr_b16 a[62:63], v25 offset:3072
    v_lshlrev_b32 v9, 1, v6
    v_xor_b32 v9, v9, v5
    v_mfma_f32_32x32x16_bf16 v[128:143], a[200:203], a[88:91], v[128:143]
    buffer_load_dwordx4 v[104:107], v31, s[84:87], s28 offen sc1
    ds_read_b64_tr_b16 a[64:65], v35 offset:0
    ds_read_b64_tr_b16 a[66:67], v35 offset:1024
    v_lshlrev_b32_e64 v9, 4, v9
    v_lshl_add_u32 v9, v5, 8, v9
    v_mfma_f32_32x32x16_bf16 v[144:159], a[204:207], a[88:91], v[144:159]
    ds_read_b64_tr_b16 a[68:69], v36 offset:0
    s_add_u32 s15, s42, 65536
    v_mfma_f32_32x32x16_bf16 v[160:175], a[200:203], a[92:95], v[160:175]
    buffer_load_dwordx4 v[108:111], v31, s[84:87], s29 offen sc1
    ds_read_b64_tr_b16 a[70:71], v36 offset:1024
    v_add_u32 v9, s15, v9
    v_xor_b32 v10, 16, v9
    v_mfma_f32_32x32x16_bf16 v[176:191], a[204:207], a[92:95], v[176:191]
    ds_read_b64_tr_b16 a[72:73], v35 offset:2048
    ds_read_b64_tr_b16 a[74:75], v35 offset:3072
    v_lshrrev_b32 v7, 5, v1
    s_lshl_b32 s15, s3, 1
    v_mfma_f32_32x32x16_bf16 v[128:143], a[208:211], a[96:99], v[128:143]
    ds_read_b64_tr_b16 a[76:77], v36 offset:2048
    v_add_u32 v11, s15, v7
    v_xor_b32 v11, v11, v6
    v_mfma_f32_32x32x16_bf16 v[144:159], a[212:215], a[96:99], v[144:159]
    buffer_load_dwordx4 v[112:115], v31, s[84:87], s30 offen sc1
    ds_read_b64_tr_b16 a[78:79], v36 offset:3072
    v_lshlrev_b32 v11, 4, v11
    v_lshl_add_u32 v11, v6, 10, v11
    s_waitcnt vmcnt(23)
    v_mfma_f32_32x32x16_bf16 v[160:175], a[208:211], a[100:103], v[160:175]
    ds_read_b64_tr_b16 a[80:81], v24 offset:16384
    ds_read_b64_tr_b16 a[82:83], v24 offset:17408
    v_and_b32 v2, 3, v5
    v_mfma_f32_32x32x16_bf16 v[176:191], a[212:215], a[100:103], v[176:191]
    buffer_load_dwordx4 v[116:119], v31, s[84:87], s31 offen sc1
    ds_read_b64_tr_b16 a[84:85], v25 offset:16384
    v_lshl_add_u32 v11, v2, 2, v11
    v_add_u32 v11, 147968, v11
    s_waitcnt vmcnt(23)
    v_mfma_f32_32x32x16_bf16 v[128:143], a[216:219], a[104:107], v[128:143]
    ds_read_b64_tr_b16 a[86:87], v25 offset:17408
    s_and_b32 s15, s6, 1
    s_lshl3_add_u32 s15, s15, s3
    v_mfma_f32_32x32x16_bf16 v[144:159], a[220:223], a[104:107], v[144:159]
    ds_read_b64_tr_b16 a[88:89], v24 offset:18432
    ds_read_b64_tr_b16 a[90:91], v24 offset:19456
    s_lshl_b32 s15, s15, 6
    s_add_u32 s15, s15, 157184
    s_waitcnt vmcnt(22)
    v_mfma_f32_32x32x16_bf16 v[160:175], a[216:219], a[108:111], v[160:175]
    buffer_load_dwordx4 v[120:123], v31, s[84:87], s32 offen sc1
    ds_read_b64_tr_b16 a[92:93], v25 offset:18432
    v_lshl_add_u32 v12, v5, 3, s15
    v_mfma_f32_32x32x16_bf16 v[176:191], a[220:223], a[108:111], v[176:191]
    ds_read_b64_tr_b16 a[94:95], v25 offset:19456
    ds_read_b64 v[88:89], v12
    ds_read_b64 v[90:91], v12 offset:256
    s_waitcnt vmcnt(22) lgkmcnt(15)
    v_mfma_f32_32x32x16_bf16 v[128:143], a[0:3], a[224:227], v[128:143]
    buffer_load_dwordx4 v[124:127], v31, s[84:87], s33 offen sc1
    ds_read_b64_tr_b16 a[96:97], v35 offset:4096
    ds_read_b64_tr_b16 a[98:99], v35 offset:5120
    v_xor_b32_e64 v7, v7, v6
    v_lshl_add_u32 v7, v7, 4, s89
    s_waitcnt vmcnt(22)
    v_mfma_f32_32x32x16_bf16 v[128:143], a[8:11], a[228:231], v[128:143]
    ds_read_b64_tr_b16 a[100:101], v36 offset:4096
    v_and_b32 v2, 31, v1
    v_lshl_add_u32 v41, v2, 8, v7
    s_waitcnt vmcnt(21)
    v_mfma_f32_32x32x16_bf16 v[128:143], a[16:19], a[232:235], v[128:143]
    ds_read_b64_tr_b16 a[102:103], v36 offset:5120
    v_xor_b32_e64 v42, 32, v41
    v_xor_b32 v43, 64, v41
    s_waitcnt vmcnt(20)
    v_mfma_f32_32x32x16_bf16 v[128:143], a[24:27], a[236:239], v[128:143]
    buffer_load_dwordx4 v[192:195], v31, s[84:87], s34 offen sc1
    ds_read_b64_tr_b16 a[104:105], v35 offset:6144
    ds_read_b64_tr_b16 a[106:107], v35 offset:7168
    v_xor_b32 v44, 96, v41
    s_waitcnt vmcnt(19)
    v_mfma_f32_32x32x16_bf16 v[128:143], a[32:35], a[240:243], v[128:143]
    ds_read_b64_tr_b16 a[108:109], v36 offset:6144
    s_lshl_b32 s15, s3, 13
    s_sub_u32 s15, s15, s89
    s_waitcnt vmcnt(18)
    v_mfma_f32_32x32x16_bf16 v[128:143], a[40:43], a[244:247], v[128:143]
    buffer_load_dwordx4 v[196:199], v31, s[84:87], s35 offen sc1
    ds_read_b64_tr_b16 a[110:111], v36 offset:7168
    s_add_u32 s15, s15, 114688
    v_add_u32 v45, s15, v41
    s_waitcnt vmcnt(18)
    v_mfma_f32_32x32x16_bf16 v[128:143], a[48:51], a[248:251], v[128:143]
    v_add_u32_e64 v46, s15, v42
    v_add_u32 v47, s15, v43
    s_waitcnt vmcnt(16)
    v_mfma_f32_32x32x16_bf16 v[128:143], a[56:59], a[252:255], v[128:143]
    v_add_u32 v48, s15, v44
    s_waitcnt vmcnt(15) lgkmcnt(15)
    v_mfma_f32_32x32x16_bf16 v[128:143], a[64:67], v[232:235], v[128:143]
    buffer_load_dwordx4 v[200:203], v31, s[84:87], s36 offen sc1
    s_waitcnt vmcnt(15)
    v_mfma_f32_32x32x16_bf16 v[128:143], a[72:75], v[236:239], v[128:143]
    s_waitcnt vmcnt(12) lgkmcnt(10)
    v_mfma_f32_32x32x16_bf16 v[128:143], a[80:83], v[240:243], v[128:143]
    buffer_load_dwordx4 v[204:207], v31, s[84:87], s37 offen sc1
    v_lshlrev_b32 v72, 16, v56
    v_and_b32 v73, 0xffff0000, v56
    s_waitcnt vmcnt(12)
    v_mfma_f32_32x32x16_bf16 v[128:143], a[88:91], v[244:247], v[128:143]
    v_lshlrev_b32 v74, 16, v57
    v_and_b32 v75, 0xffff0000, v57
    s_waitcnt vmcnt(11) lgkmcnt(0)
    v_mfma_f32_32x32x16_bf16 v[128:143], a[96:99], v[248:251], v[128:143]
    v_lshlrev_b32 v76, 16, v58
    v_and_b32 v77, 0xffff0000, v58
    s_waitcnt vmcnt(10)
    v_mfma_f32_32x32x16_bf16 v[128:143], a[104:107], v[252:255], v[128:143]
    buffer_load_dwordx4 v[208:211], v31, s[84:87], s38 offen sc1
    v_lshlrev_b32_e64 v78, 16, v59
    v_mfma_f32_32x32x16_bf16 v[144:159], a[4:7], a[224:227], v[144:159]
    v_and_b32 v79, 0xffff0000, v59
    v_fma_f32 v16, v72, v88, v89
    v_mfma_f32_32x32x16_bf16 v[144:159], a[12:15], a[228:231], v[144:159]
    buffer_load_dwordx4 v[212:215], v31, s[84:87], s39 offen sc1
    v_fma_f32 v17, v73, v88, v89
    v_fma_f32 v18, v74, v88, v89
    s_nop 2
    s_nop 0
    ds_write_b128 v41, v[128:131] offset:0
    v_mfma_f32_32x32x16_bf16 v[144:159], a[20:23], a[232:235], v[144:159]
    v_fma_f32 v19, v75, v88, v89
    v_mfma_f32_32x32x16_bf16 v[144:159], a[28:31], a[236:239], v[144:159]
    v_fma_f32 v20, v76, v88, v89
    v_fma_f32 v21, v77, v88, v89
    ds_write_b128 v42, v[132:135] offset:0
    v_mfma_f32_32x32x16_bf16 v[144:159], a[36:39], a[240:243], v[144:159]
    buffer_load_dwordx4 v[216:219], v31, s[84:87], s40 offen sc1
    v_fma_f32 v22, v78, v88, v89
    v_fma_f32 v23, v79, v88, v89
    v_mfma_f32_32x32x16_bf16 v[144:159], a[44:47], a[244:247], v[144:159]
    v_lshlrev_b32_e64 v80, 16, v60
    ds_write_b128 v43, v[136:139] offset:0
    v_mfma_f32_32x32x16_bf16 v[144:159], a[52:55], a[248:251], v[144:159]
    buffer_load_dwordx4 v[220:223], v31, s[84:87], s41 offen sc1
    v_and_b32 v81, 0xffff0000, v60
    v_lshlrev_b32_e64 v82, 16, v61
    v_mfma_f32_32x32x16_bf16 v[144:159], a[60:63], a[252:255], v[144:159]
    v_and_b32 v83, 0xffff0000, v61
    v_lshlrev_b32_e64 v84, 16, v62
    ds_write_b128 v44, v[140:143] offset:0
    v_mfma_f32_32x32x16_bf16 v[144:159], a[68:71], v[232:235], v[144:159]
    buffer_load_dwordx4 v[64:67], v3, s[84:87], s92 offen sc1
    buffer_load_dwordx4 v[68:71], v4, s[84:87], s92 offen sc1
    v_and_b32 v85, 0xffff0000, v62
    v_mfma_f32_32x32x16_bf16 v[144:159], a[76:79], v[236:239], v[144:159]
    v_lshlrev_b32_e64 v86, 16, v63
    v_and_b32 v87, 0xffff0000, v63
    v_mfma_f32_32x32x16_bf16 v[144:159], a[84:87], v[240:243], v[144:159]
    v_fma_f32 v24, v80, v90, v91
    v_fma_f32 v25, v81, v90, v91
    v_mfma_f32_32x32x16_bf16 v[144:159], a[92:95], v[244:247], v[144:159]
    v_fma_f32 v26, v82, v90, v91
    v_mfma_f32_32x32x16_bf16 v[144:159], a[100:103], v[248:251], v[144:159]
    v_fma_f32 v27, v83, v90, v91
    v_fma_f32 v28, v84, v90, v91
    v_mfma_f32_32x32x16_bf16 v[144:159], a[108:111], v[252:255], v[144:159]
    v_fma_f32 v29, v85, v90, v91
    v_fma_f32 v30, v86, v90, v91
    s_waitcnt vmcnt(15)
    v_mfma_f32_32x32x16_bf16 v[160:175], a[0:3], v[104:107], v[160:175]
    v_fma_f32 v31, v87, v90, v91
    s_waitcnt vmcnt(14)
    v_mfma_f32_32x32x16_bf16 v[160:175], a[8:11], v[108:111], v[160:175]
    s_nop 4
    ds_write_b128 v41, v[144:147] offset:128
    s_waitcnt vmcnt(13)
    v_mfma_f32_32x32x16_bf16 v[160:175], a[16:19], v[112:115], v[160:175]
    ds_write_b128 v42, v[148:151] offset:128
    s_waitcnt vmcnt(12)
    v_mfma_f32_32x32x16_bf16 v[160:175], a[24:27], v[116:119], v[160:175]
    ds_write_b128 v43, v[152:155] offset:128
    s_waitcnt vmcnt(11)
    v_mfma_f32_32x32x16_bf16 v[160:175], a[32:35], v[120:123], v[160:175]
    ds_write_b128 v44, v[156:159] offset:128
    s_waitcnt vmcnt(10)
    v_mfma_f32_32x32x16_bf16 v[160:175], a[40:43], v[124:127], v[160:175]
    s_waitcnt vmcnt(9)
    v_mfma_f32_32x32x16_bf16 v[160:175], a[48:51], v[192:195], v[160:175]
    s_waitcnt lgkmcnt(0)
    s_barrier
    ds_read_b128 v[224:227], v9 offset:0
    ds_read_b128 v[228:231], v10 offset:0
    s_waitcnt vmcnt(8)
    v_mfma_f32_32x32x16_bf16 v[160:175], a[56:59], v[196:199], v[160:175]
    ds_read_b128 v[232:235], v9 offset:12288
    ds_read_b128 v[236:239], v10 offset:12288
    s_waitcnt vmcnt(7)
    v_mfma_f32_32x32x16_bf16 v[160:175], a[64:67], v[200:203], v[160:175]
    ds_read_b128 v[240:243], v9 offset:24576
    ds_read_b128 v[244:247], v10 offset:24576
    s_waitcnt vmcnt(6)
    v_mfma_f32_32x32x16_bf16 v[160:175], a[72:75], v[204:207], v[160:175]
    ds_read_b128 v[248:251], v9 offset:36864
    ds_read_b128 v[252:255], v10 offset:36864
    s_waitcnt vmcnt(5)
    v_mfma_f32_32x32x16_bf16 v[160:175], a[80:83], v[208:211], v[160:175]
    s_waitcnt vmcnt(4)
    v_mfma_f32_32x32x16_bf16 v[160:175], a[88:91], v[212:215], v[160:175]
    s_waitcnt vmcnt(3)
    v_mfma_f32_32x32x16_bf16 v[160:175], a[96:99], v[216:219], v[160:175]
    s_waitcnt lgkmcnt(0)
    v_add_f32 v224, v224, v232
    v_add_f32_e64 v225, v225, v233
    v_add_f32 v226, v226, v234
    s_waitcnt vmcnt(2)
    v_mfma_f32_32x32x16_bf16 v[160:175], a[104:107], v[220:223], v[160:175]
    v_add_u32 v9, 49152, v9
    v_add_u32 v10, 49152, v10
    v_add_f32 v227, v227, v235
    v_add_f32 v228, v228, v236
    v_add_f32_e64 v229, v229, v237
    v_mfma_f32_32x32x16_bf16 v[176:191], a[4:7], v[104:107], v[176:191]
    v_add_f32 v230, v230, v238
    v_add_f32 v231, v231, v239
    v_mfma_f32_32x32x16_bf16 v[176:191], a[12:15], v[108:111], v[176:191]
    s_nop 2
    ds_write_b128 v45, v[160:163] offset:0
    v_add_f32 v240, v240, v248
    v_add_f32 v241, v241, v249
    v_add_f32 v242, v242, v250
    v_mfma_f32_32x32x16_bf16 v[176:191], a[20:23], v[112:115], v[176:191]
    v_add_f32 v243, v243, v251
    v_add_f32 v244, v244, v252
    v_mfma_f32_32x32x16_bf16 v[176:191], a[28:31], v[116:119], v[176:191]
    ds_write_b128 v46, v[164:167] offset:0
    v_add_f32 v245, v245, v253
    v_add_f32 v246, v246, v254
    v_add_f32_e64 v247, v247, v255
    v_mfma_f32_32x32x16_bf16 v[176:191], a[36:39], v[120:123], v[176:191]
    v_add_f32 v224, v224, v240
    v_add_f32 v225, v225, v241
    v_mfma_f32_32x32x16_bf16 v[176:191], a[44:47], v[124:127], v[176:191]
    ds_write_b128 v47, v[168:171] offset:0
    v_add_f32 v226, v226, v242
    v_add_f32 v227, v227, v243
    v_add_f32 v228, v228, v244
    v_mfma_f32_32x32x16_bf16 v[176:191], a[52:55], v[192:195], v[176:191]
    s_waitcnt vmcnt(0)
    v_max3_u32 v2, v64, v65, v66
    v_max3_u32 v5, v67, v68, v69
    v_max3_u32 v2, v2, v70, v71
    v_mfma_f32_32x32x16_bf16 v[176:191], a[60:63], v[196:199], v[176:191]
    ds_write_b128 v48, v[172:175] offset:0
    v_max_u32 v2, v2, v5
    v_cmp_eq_u32 vcc, -1, v2
    s_mov_b32 s95, 0
    s_cbranch_vccnz Lyslow
Lyback:
    v_mfma_f32_32x32x16_bf16 v[176:191], a[68:71], v[200:203], v[176:191]
    v_add_f32 v229, v229, v245
    v_add_f32 v230, v230, v246
    v_add_f32_e64 v231, v231, v247
    v_mfma_f32_32x32x16_bf16 v[176:191], a[76:79], v[204:207], v[176:191]
    ds_write_b128 v13, v[64:67]
    v_mul_f32 v128, 0xbfb8aa3b, v224
    v_mul_f32 v129, 0xbfb8aa3b, v225
    v_mfma_f32_32x32x16_bf16 v[176:191], a[84:87], v[208:211], v[176:191]
    v_exp_f32 v128, v128
    v_exp_f32 v129, v129
    v_mul_f32 v130, 0xbfb8aa3b, v226
    v_mfma_f32_32x32x16_bf16 v[176:191], a[92:95], v[212:215], v[176:191]
    ds_write_b128 v13, v[68:71] offset:1024
    v_mul_f32 v131, 0xbfb8aa3b, v227
    v_exp_f32_e64 v130, v130
    v_mfma_f32_32x32x16_bf16 v[176:191], a[100:103], v[216:219], v[176:191]
    v_exp_f32_e64 v131, v131
    v_mul_f32 v132, 0xbfb8aa3b, v228
    v_mul_f32 v133, 0xbfb8aa3b, v229
    v_mfma_f32_32x32x16_bf16 v[176:191], a[108:111], v[220:223], v[176:191]
    v_exp_f32 v132, v132
    v_exp_f32 v133, v133
    v_mul_f32 v134, 0xbfb8aa3b, v230
    v_mul_f32 v135, 0xbfb8aa3b, v231
    v_exp_f32_e64 v134, v134
    v_exp_f32 v135, v135
    v_pk_mul_f32 v[16:17], v[16:17], v[224:225]
    v_pk_mul_f32 v[18:19], v[18:19], v[226:227]
    v_pk_mul_f32 v[20:21], v[20:21], v[228:229]
    v_pk_mul_f32 v[22:23], v[22:23], v[230:231]
    s_nop 1
    ds_write_b128 v45, v[176:179] offset:128
    v_pk_add_f32 v[128:129], v[128:129], 1.0 op_sel_hi:[1,0]
    v_pk_add_f32 v[130:131], v[130:131], 1.0 op_sel_hi:[1,0]
    ds_write_b128 v46, v[180:183] offset:128
    v_pk_add_f32 v[132:133], v[132:133], 1.0 op_sel_hi:[1,0]
    v_pk_add_f32 v[134:135], v[134:135], 1.0 op_sel_hi:[1,0]
    v_rcp_f32_e64 v128, v128
    ds_write_b128 v47, v[184:187] offset:128
    v_rcp_f32 v129, v129
    v_rcp_f32 v130, v130
    ds_write_b128 v48, v[188:191] offset:128
    v_rcp_f32 v131, v131
    v_rcp_f32 v132, v132
    v_rcp_f32 v133, v133
    v_rcp_f32 v134, v134
    v_rcp_f32_e64 v135, v135
    v_pk_mul_f32 v[16:17], v[16:17], v[128:129]
    v_pk_mul_f32 v[18:19], v[18:19], v[130:131]
    v_pk_mul_f32 v[20:21], v[20:21], v[132:133]
    v_pk_mul_f32 v[22:23], v[22:23], v[134:135]
    s_waitcnt lgkmcnt(0)
    s_barrier
    ds_read_b32 v96, v11 offset:0
    ds_read_b32 v97, v11 offset:256
    ds_read_b32 v98, v11 offset:512
    ds_read_b32 v99, v11 offset:768
    ds_read_b32 v100, v11 offset:128
    ds_read_b32 v101, v11 offset:384
    ds_read_b32 v102, v11 offset:640
    ds_read_b32 v103, v11 offset:896
    ds_read_b128 v[224:227], v9 offset:0
    ds_read_b128 v[228:231], v10 offset:0
    ds_read_b128 v[232:235], v9 offset:8192
    ds_read_b128 v[236:239], v10 offset:8192
    ds_read_b128 v[240:243], v9 offset:16384
    ds_read_b128 v[244:247], v10 offset:16384
    ds_read_b128 v[248:251], v9 offset:24576
    ds_read_b128 v[252:255], v10 offset:24576
    s_waitcnt lgkmcnt(12)
    v_lshlrev_b32 v56, 16, v96
    v_and_b32 v57, 0xffff0000, v96
    v_lshlrev_b32_e64 v58, 16, v97
    v_and_b32 v59, 0xffff0000, v97
    v_lshlrev_b32_e64 v60, 16, v98
    v_and_b32 v61, 0xffff0000, v98
    v_lshlrev_b32_e64 v62, 16, v99
    v_and_b32 v63, 0xffff0000, v99
    v_pk_fma_f32 v[72:73], v[16:17], v[56:57], v[72:73]
    v_pk_fma_f32 v[74:75], v[18:19], v[58:59], v[74:75]
    v_pk_fma_f32 v[76:77], v[20:21], v[60:61], v[76:77]
    v_pk_fma_f32 v[78:79], v[22:23], v[62:63], v[78:79]
    v_cvt_pk_bf16_f32 v136, v72, v73
    v_cvt_pk_bf16_f32 v137, v74, v75
    v_cvt_pk_bf16_f32 v138, v76, v77
    v_cvt_pk_bf16_f32 v139, v78, v79
    buffer_store_dwordx4 v[136:139], v8, s[76:79], s93 offen
    s_waitcnt lgkmcnt(8)
    v_lshlrev_b32 v56, 16, v100
    v_and_b32 v57, 0xffff0000, v100
    v_lshlrev_b32_e64 v58, 16, v101
    v_and_b32 v59, 0xffff0000, v101
    v_lshlrev_b32_e64 v60, 16, v102
    v_and_b32 v61, 0xffff0000, v102
    v_lshlrev_b32 v62, 16, v103
    v_and_b32 v63, 0xffff0000, v103
    v_pk_mul_f32 v[24:25], v[24:25], v[56:57]
    v_pk_mul_f32 v[26:27], v[26:27], v[58:59]
    v_pk_mul_f32 v[28:29], v[28:29], v[60:61]
    v_pk_mul_f32 v[30:31], v[30:31], v[62:63]
    s_waitcnt lgkmcnt(0)
    v_pk_add_f32 v[224:225], v[224:225], v[232:233]
    v_pk_add_f32 v[240:241], v[240:241], v[248:249]
    v_pk_add_f32 v[226:227], v[226:227], v[234:235]
    v_pk_add_f32 v[242:243], v[242:243], v[250:251]
    v_pk_add_f32 v[228:229], v[228:229], v[236:237]
    v_pk_add_f32 v[244:245], v[244:245], v[252:253]
    v_pk_add_f32 v[230:231], v[230:231], v[238:239]
    v_pk_add_f32 v[246:247], v[246:247], v[254:255]
    v_pk_add_f32 v[224:225], v[224:225], v[240:241]
    v_pk_add_f32 v[226:227], v[226:227], v[242:243]
    v_pk_add_f32 v[228:229], v[228:229], v[244:245]
    v_pk_add_f32 v[230:231], v[230:231], v[246:247]
    v_mul_f32 v128, 0xbfb8aa3b, v224
    v_mul_f32 v129, 0xbfb8aa3b, v225
    v_mul_f32 v130, 0xbfb8aa3b, v226
    v_mul_f32 v131, 0xbfb8aa3b, v227
    v_mul_f32 v132, 0xbfb8aa3b, v228
    v_mul_f32 v133, 0xbfb8aa3b, v229
    v_mul_f32 v134, 0xbfb8aa3b, v230
    v_mul_f32 v135, 0xbfb8aa3b, v231
    v_exp_f32 v128, v128
    v_exp_f32 v129, v129
    v_exp_f32 v130, v130
    v_exp_f32 v131, v131
    v_exp_f32 v132, v132
    v_exp_f32 v133, v133
    v_exp_f32 v134, v134
    v_exp_f32 v135, v135
    v_pk_mul_f32 v[24:25], v[24:25], v[224:225]
    v_pk_mul_f32 v[26:27], v[26:27], v[226:227]
    v_pk_mul_f32 v[28:29], v[28:29], v[228:229]
    v_pk_mul_f32 v[30:31], v[30:31], v[230:231]
    v_pk_add_f32 v[128:129], v[128:129], 1.0 op_sel_hi:[1,0]
    v_pk_add_f32 v[130:131], v[130:131], 1.0 op_sel_hi:[1,0]
    v_pk_add_f32 v[132:133], v[132:133], 1.0 op_sel_hi:[1,0]
    v_pk_add_f32 v[134:135], v[134:135], 1.0 op_sel_hi:[1,0]
    v_rcp_f32 v128, v128
    v_rcp_f32 v129, v129
    v_rcp_f32 v130, v130
    v_rcp_f32 v131, v131
    v_rcp_f32 v132, v132
    v_rcp_f32 v133, v133
    v_rcp_f32 v134, v134
    v_rcp_f32 v135, v135
    v_pk_fma_f32 v[80:81], v[24:25], v[128:129], v[80:81]
    v_pk_fma_f32 v[82:83], v[26:27], v[130:131], v[82:83]
    v_pk_fma_f32 v[84:85], v[28:29], v[132:133], v[84:85]
    v_pk_fma_f32 v[86:87], v[30:31], v[134:135], v[86:87]
    v_cvt_pk_bf16_f32 v140, v80, v81
    v_cvt_pk_bf16_f32 v141, v82, v83
    v_cvt_pk_bf16_f32 v142, v84, v85
    v_cvt_pk_bf16_f32 v143, v86, v87
    buffer_store_dwordx4 v[140:143], v8, s[76:79], s94 offen
Lend:
    s_endpgm
Lslow0:
    s_mov_b32 s95, 0
Lspin0:
    s_sleep 8
    buffer_load_dword v40, off, s[80:83], 0 sc1
    s_add_u32 s95, s95, 1
    s_waitcnt vmcnt(0)
    v_cmp_gt_u32 vcc, 1, v40
    s_cmp_gt_u32 s95, 0x40000
    s_cbranch_scc1 Lback0
    s_cbranch_vccnz Lspin0
    s_branch Lback0
Lslow1:
    s_mov_b32 s95, 0
Lspin1:
    s_sleep 8
    buffer_load_dword v40, v38, s[84:87], 0 offen sc1
    s_add_u32 s95, s95, 1
    s_waitcnt vmcnt(0)
    v_cmp_gt_u32 vcc, 1, v40
    s_cmp_gt_u32 s95, 0x40000
    s_cbranch_scc1 Lback1
    s_cbranch_vccnz Lspin1
    s_branch Lback1
Lslow2:
    s_mov_b32 s95, 0
Lspin2:
    s_sleep 1
    buffer_load_dword v40, v39, s[84:87], 0 offen sc1
    s_add_u32 s95, s95, 1
    s_waitcnt vmcnt(0)
    v_cmp_gt_u32 vcc, 2, v40
    s_cmp_gt_u32 s95, 0x40000
    s_cbranch_scc1 Lback2
    s_cbranch_vccnz Lspin2
    s_branch Lback2
Lslow3:
    s_mov_b32 s95, 0
Lspin3:
    s_sleep 1
    buffer_load_dword v40, v38, s[84:87], 0 offen sc1
    s_add_u32 s95, s95, 1
    s_waitcnt vmcnt(0)
    v_cmp_gt_u32 vcc, v37, v40
    s_cmp_gt_u32 s95, 0x40000
    s_cbranch_scc1 Lback3
    s_cbranch_vccnz Lspin3
    s_branch Lback3
Lyslow:
    s_mov_b32 s95, 0
Lyspin:
    buffer_load_dwordx4 v[64:67], v3, s[84:87], s92 offen sc1
    buffer_load_dwordx4 v[68:71], v4, s[84:87], s92 offen sc1
    s_add_u32 s95, s95, 1
    s_waitcnt vmcnt(0)
    v_max3_u32 v2, v64, v65, v66
    v_max3_u32 v5, v67, v68, v69
    v_max3_u32 v2, v2, v70, v71
    v_max_u32 v2, v2, v5
    v_cmp_eq_u32 vcc, -1, v2
    s_cmp_gt_u32 s95, 0x40000
    s_cbranch_scc1 Lyback
    s_cbranch_vccnz Lyspin
    s_branch Lyback
Lslow5:
    s_mov_b32 s95, 0
Lspin5:
    s_sleep 8
    buffer_load_dword v40, off, s[80:83], 0 sc1
    s_add_u32 s95, s95, 1
    s_waitcnt vmcnt(0)
    v_cmp_gt_u32 vcc, 1, v40
    s_cmp_gt_u32 s95, 0x40000
    s_cbranch_scc1 Lback5
    s_cbranch_vccnz Lspin5
    s_branch Lback5
Lhelper:
    s_sub_u32 s6, s2, 224
    v_lshlrev_b32 v9, 2, v7
    v_xor_b32 v9, v9, v6
    v_lshl_add_u32 v9, v9, 4, v8
    s_lshl2_add_u32 s15, s6, s3
    s_mul_i32 s42, s15, 14336
    v_add_u32_e64 v10, s42, v9
    v_add_u32 v11, 6144, v10
    v_subrev_u32 v12, 7168, v10
    s_mul_i32 s89, s3, 5120
    v_lshlrev_b32 v9, 3, v1
    s_waitcnt lgkmcnt(0)
    s_add_u32 s12, s40, 0x1F0000
    s_addc_u32 s13, s41, 0
    v_mov_b32 v2, s18
    v_mov_b32_e64 v3, s19
    v_writelane_b32 v2, s20, 1
    v_writelane_b32 v3, s21, 1
    v_writelane_b32 v2, s22, 2
    v_writelane_b32 v3, s23, 2
    v_writelane_b32 v2, s12, 3
    v_writelane_b32 v3, s13, 3
    s_mov_b64 exec, 15
    global_load_dword v249, v[2:3], off
    s_mov_b64 exec, -1
    s_mov_b32 s48, s18
    s_and_b32 s49, s19, 0xffff
    s_mov_b32 s50, 1835008
    s_mov_b32 s51, 0x20000
    s_mov_b32 s52, s20
    s_and_b32 s53, s21, 0xffff
    s_mov_b32 s54, 1835008
    s_mov_b32 s55, 0x20000
    s_mov_b32 s56, s22
    s_and_b32 s57, s23, 0xffff
    s_mov_b32 s58, 3584
    s_mov_b32 s59, 0x20000
    s_mov_b32 s80, s38
    s_and_b32 s81, s39, 0xffff
    s_mov_b32 s82, 256
    s_mov_b32 s83, 0x20000
    s_mov_b32 s84, s40
    s_and_b32 s85, s41, 0xffff
    s_mov_b32 s86, 16777216
    s_mov_b32 s87, 0x20000
    s_lshl_b32 s42, s6, 24
    s_add_u32 s43, s42, 1966080
    v_lshl_add_u32 v13, v0, 7, s43
    v_mov_b32_e64 v15, 0
    buffer_store_dword v15, v13, s[84:87], 0 offen sc1
    s_add_u32 m0, s89, 0
    s_movk_i32 s91, 0
    buffer_load_dwordx4 v12, s[48:51], s91 offen lds
    s_add_u32 m0, s89, 1024
    buffer_load_dwordx2 v[64:65], v9, s[56:59], 0 offen offset:0
    buffer_load_dwordx4 v10, s[48:51], s91 offen lds
    buffer_load_dwordx4 v11, s[48:51], s91 offen offset:1024 lds
    s_add_u32 m0, s89, 3072
    s_nop 0
    buffer_load_dwordx4 v10, s[52:55], s91 offen lds
    buffer_load_dwordx4 v11, s[52:55], s91 offen offset:1024 lds
    s_add_u32 m0, s89, 20480
    s_movk_i32 s91, 128
    buffer_load_dwordx4 v12, s[48:51], s91 offen lds
    s_add_u32 m0, s89, 21504
    buffer_load_dwordx2 v[66:67], v9, s[56:59], 0 offen offset:512
    buffer_load_dwordx4 v10, s[48:51], s91 offen lds
    buffer_load_dwordx4 v11, s[48:51], s91 offen offset:1024 lds
    s_add_u32 m0, s89, 23552
    s_nop 0
    buffer_load_dwordx4 v10, s[52:55], s91 offen lds
    buffer_load_dwordx4 v11, s[52:55], s91 offen offset:1024 lds
    v_lshl_add_u32 v37, v0, 8, s42
    s_lshl_b32 s42, s2, 7
    s_add_u32 s42, s42, 1966080
    v_lshl_add_u32 v39, v0, 24, s42
    v_and_b32_e64 v2, 3, v1
    v_bfe_u32 v3, v1, 2, 2
    v_lshl_add_u32 v2, v2, 3, s89
    v_lshl_add_u32 v2, v3, 7, v2
    v_and_b32 v3, 2, v3
    v_lshrrev_b32 v4, 4, v1
    v_xor_b32_e64 v3, v3, v4
    v_lshl_add_u32 v16, v3, 5, v2
    s_lshl_b32 s42, s3, 1
    v_xor_b32 v2, s42, v6
    v_lshlrev_b32_e64 v2, 4, v2
    v_lshl_add_u32 v2, v1, 7, v2
    v_add_u32 v17, 143360, v2
    v_xor_b32 v18, 16, v17
    v_xor_b32 v2, v5, v6
    v_lshlrev_b32 v2, 4, v2
    v_lshl_add_u32 v2, v5, 7, v2
    s_lshl_b32 s42, s3, 11
    s_add_u32 s42, s42, 143360
    v_add_u32 v19, s42, v2
    v_lshlrev_b32 v2, 4, v6
    v_lshl_add_u32 v20, v5, 12, v2
    v_add_u32 v21, 32768, v20
    s_lshl_b32 s94, s3, 16
    s_lshl_b32 s42, s6, 7
    s_add_u32 s94, s94, s42
    s_waitcnt vmcnt(6)
    ds_read_b64_tr_b16 v[96:97], v16 offset:512
    ds_read_b64_tr_b16 v[98:99], v16 offset:1024
    ds_read_b64_tr_b16 v[100:101], v16 offset:1536
    ds_read_b64_tr_b16 v[102:103], v16 offset:2048
    ds_read_b64_tr_b16 v[104:105], v16 offset:2560
    ds_read_b64_tr_b16 v[106:107], v16 offset:3072
    ds_read_b64_tr_b16 v[108:109], v16 offset:3584
    ds_read_b64_tr_b16 v[110:111], v16 offset:4096
    ds_read_b64_tr_b16 v[112:113], v16 offset:4608
    v_add_u32 v16, 20480, v16
    v_alignbit_b32 v24, v65, v65, 16
    v_alignbit_b32 v25, v64, v64, 16
    v_and_b32 v26, 0xffff0000, v65
    v_and_b32 v28, 0xffff, v64
    v_alignbit_b32 v27, v25, v24, 16
    s_waitcnt lgkmcnt(0)
    s_nop 0
    v_dot2_f32_bf16 v160, v96, v26, 0
    v_dot2_f32_bf16 v161, v97, v24, 0
    v_dot2_f32_bf16 v162, v97, v26, 0
    v_dot2_f32_bf16 v163, v98, v24, 0
    v_dot2_f32_bf16 v164, v98, v26, 0
    v_dot2_f32_bf16 v165, v99, v24, 0
    v_dot2_f32_bf16 v166, v99, v26, 0
    v_dot2_f32_bf16 v167, v100, v24, 0
    v_dot2_f32_bf16 v168, v100, v26, 0
    v_dot2_f32_bf16 v169, v101, v24, 0
    v_dot2_f32_bf16 v170, v101, v26, 0
    v_dot2_f32_bf16 v171, v102, v24, 0
    v_dot2_f32_bf16 v172, v102, v26, 0
    v_dot2_f32_bf16 v173, v103, v24, 0
    v_dot2_f32_bf16 v174, v103, v26, 0
    v_dot2_f32_bf16 v175, v104, v24, 0
    s_add_u32 m0, s89, 40960
    s_movk_i32 s91, 256
    buffer_load_dwordx4 v12, s[48:51], s91 offen lds
    s_add_u32 m0, s89, 41984
    buffer_load_dwordx2 v[68:69], v9, s[56:59], 0 offen offset:1024
    buffer_load_dwordx4 v10, s[48:51], s91 offen lds
    buffer_load_dwordx4 v11, s[48:51], s91 offen offset:1024 lds
    s_add_u32 m0, s89, 44032
    s_nop 0
    buffer_load_dwordx4 v10, s[52:55], s91 offen lds
    buffer_load_dwordx4 v11, s[52:55], s91 offen offset:1024 lds
    v_dot2c_f32_bf16 v160, v97, v27
    v_dot2c_f32_bf16 v161, v98, v25
    v_dot2c_f32_bf16 v162, v98, v27
    v_dot2c_f32_bf16 v163, v99, v25
    v_dot2c_f32_bf16 v164, v99, v27
    v_dot2c_f32_bf16 v165, v100, v25
    v_dot2c_f32_bf16 v166, v100, v27
    v_dot2c_f32_bf16 v167, v101, v25
    v_dot2c_f32_bf16 v168, v101, v27
    v_dot2c_f32_bf16 v169, v102, v25
    v_dot2c_f32_bf16 v170, v102, v27
    v_dot2c_f32_bf16 v171, v103, v25
    v_dot2c_f32_bf16 v172, v103, v27
    v_dot2c_f32_bf16 v173, v104, v25
    v_dot2c_f32_bf16 v174, v104, v27
    v_dot2c_f32_bf16 v175, v105, v25
    v_dot2c_f32_bf16 v160, v98, v28
    v_dot2c_f32_bf16 v162, v99, v28
    v_dot2c_f32_bf16 v164, v100, v28
    v_dot2c_f32_bf16 v166, v101, v28
    v_dot2c_f32_bf16 v168, v102, v28
    v_dot2c_f32_bf16 v170, v103, v28
    v_dot2c_f32_bf16 v172, v104, v28
    v_dot2c_f32_bf16 v174, v105, v28
    v_lshlrev_b32_e64 v176, 16, v106
    v_and_b32 v177, 0xffff0000, v106
    v_lshlrev_b32_e64 v178, 16, v107
    v_and_b32 v179, 0xffff0000, v107
    v_lshlrev_b32_e64 v180, 16, v108
    v_and_b32 v181, 0xffff0000, v108
    v_lshlrev_b32_e64 v182, 16, v109
    v_and_b32 v183, 0xffff0000, v109
    v_lshlrev_b32_e64 v184, 16, v110
    v_and_b32 v185, 0xffff0000, v110
    v_lshlrev_b32_e64 v186, 16, v111
    v_and_b32 v187, 0xffff0000, v111
    v_lshlrev_b32_e64 v188, 16, v112
    v_and_b32 v189, 0xffff0000, v112
    v_lshlrev_b32 v190, 16, v113
    v_and_b32 v191, 0xffff0000, v113
    s_add_u32 m0, s89, 61440
    s_movk_i32 s91, 384
    buffer_load_dwordx4 v12, s[48:51], s91 offen lds
    s_add_u32 m0, s89, 62464
    buffer_load_dwordx2 v[70:71], v9, s[56:59], 0 offen offset:1536
    buffer_load_dwordx4 v10, s[48:51], s91 offen lds
    buffer_load_dwordx4 v11, s[48:51], s91 offen offset:1024 lds
    s_add_u32 m0, s89, 64512
    s_nop 0
    buffer_load_dwordx4 v10, s[52:55], s91 offen lds
    buffer_load_dwordx4 v11, s[52:55], s91 offen offset:1024 lds
    s_waitcnt vmcnt(12)
    ds_read_b64_tr_b16 v[116:117], v16 offset:512
    ds_read_b64_tr_b16 v[118:119], v16 offset:1024
    ds_read_b64_tr_b16 v[120:121], v16 offset:1536
    ds_read_b64_tr_b16 v[122:123], v16 offset:2048
    ds_read_b64_tr_b16 v[124:125], v16 offset:2560
    ds_read_b64_tr_b16 v[126:127], v16 offset:3072
    ds_read_b64_tr_b16 v[128:129], v16 offset:3584
    ds_read_b64_tr_b16 v[130:131], v16 offset:4096
    ds_read_b64_tr_b16 v[132:133], v16 offset:4608
    v_add_u32 v16, 20480, v16
    v_pk_mul_f32 v[160:161], v[160:161], v[176:177]
    v_pk_mul_f32 v[162:163], v[162:163], v[178:179]
    v_pk_mul_f32 v[164:165], v[164:165], v[180:181]
    v_pk_mul_f32 v[166:167], v[166:167], v[182:183]
    v_pk_mul_f32 v[168:169], v[168:169], v[184:185]
    v_pk_mul_f32 v[170:171], v[170:171], v[186:187]
    v_pk_mul_f32 v[172:173], v[172:173], v[188:189]
    v_pk_mul_f32 v[174:175], v[174:175], v[190:191]
    v_cvt_pk_bf16_f32 v152, v160, v161
    v_cvt_pk_bf16_f32 v153, v162, v163
    v_cvt_pk_bf16_f32 v154, v164, v165
    v_cvt_pk_bf16_f32 v155, v166, v167
    v_cvt_pk_bf16_f32 v156, v168, v169
    v_cvt_pk_bf16_f32 v157, v170, v171
    v_cvt_pk_bf16_f32 v158, v172, v173
    v_cvt_pk_bf16_f32 v159, v174, v175
    ds_write_b128 v17, v[152:155] offset:0
    ds_write_b128 v18, v[156:159] offset:0
    s_waitcnt lgkmcnt(0)
    s_barrier
    v_mov_b32_e64 v2, 1
    buffer_store_dword v2, v37, s[80:83], 0 offen sc1
    ds_read_b128 v[192:195], v19 offset:0
    ds_read_b128 v[196:199], v19 offset:1024
    v_alignbit_b32 v24, v67, v67, 16
    v_alignbit_b32 v25, v66, v66, 16
    v_and_b32 v26, 0xffff0000, v67
    v_and_b32 v28, 0xffff, v66
    v_alignbit_b32 v27, v25, v24, 16
    v_dot2_f32_bf16 v160, v116, v26, 0
    v_dot2_f32_bf16 v161, v117, v24, 0
    v_dot2_f32_bf16 v162, v117, v26, 0
    v_dot2_f32_bf16 v163, v118, v24, 0
    v_dot2_f32_bf16 v164, v118, v26, 0
    v_dot2_f32_bf16 v165, v119, v24, 0
    v_dot2_f32_bf16 v166, v119, v26, 0
    v_dot2_f32_bf16 v167, v120, v24, 0
    v_dot2_f32_bf16 v168, v120, v26, 0
    v_dot2_f32_bf16 v169, v121, v24, 0
    v_dot2_f32_bf16 v170, v121, v26, 0
    v_dot2_f32_bf16 v171, v122, v24, 0
    v_dot2_f32_bf16 v172, v122, v26, 0
    v_dot2_f32_bf16 v173, v123, v24, 0
    v_dot2_f32_bf16 v174, v123, v26, 0
    v_dot2_f32_bf16 v175, v124, v24, 0
    s_add_u32 m0, s89, 81920
    s_movk_i32 s91, 512
    buffer_load_dwordx4 v12, s[48:51], s91 offen lds
    s_add_u32 m0, s89, 82944
    buffer_load_dwordx2 v[72:73], v9, s[56:59], 0 offen offset:2048
    buffer_load_dwordx4 v10, s[48:51], s91 offen lds
    buffer_load_dwordx4 v11, s[48:51], s91 offen offset:1024 lds
    s_add_u32 m0, s89, 84992
    s_nop 0
    buffer_load_dwordx4 v10, s[52:55], s91 offen lds
    buffer_load_dwordx4 v11, s[52:55], s91 offen offset:1024 lds
    v_dot2c_f32_bf16 v160, v117, v27
    v_dot2c_f32_bf16 v161, v118, v25
    v_dot2c_f32_bf16 v162, v118, v27
    v_dot2c_f32_bf16 v163, v119, v25
    v_dot2c_f32_bf16 v164, v119, v27
    v_dot2c_f32_bf16 v165, v120, v25
    v_dot2c_f32_bf16 v166, v120, v27
    v_dot2c_f32_bf16 v167, v121, v25
    v_dot2c_f32_bf16 v168, v121, v27
    v_dot2c_f32_bf16 v169, v122, v25
    v_dot2c_f32_bf16 v170, v122, v27
    v_dot2c_f32_bf16 v171, v123, v25
    v_dot2c_f32_bf16 v172, v123, v27
    v_dot2c_f32_bf16 v173, v124, v25
    v_dot2c_f32_bf16 v174, v124, v27
    v_dot2c_f32_bf16 v175, v125, v25
    v_dot2c_f32_bf16 v160, v118, v28
    v_dot2c_f32_bf16 v162, v119, v28
    v_dot2c_f32_bf16 v164, v120, v28
    v_dot2c_f32_bf16 v166, v121, v28
    v_dot2c_f32_bf16 v168, v122, v28
    v_dot2c_f32_bf16 v170, v123, v28
    v_dot2c_f32_bf16 v172, v124, v28
    v_dot2c_f32_bf16 v174, v125, v28
    v_lshlrev_b32_e64 v176, 16, v126
    v_and_b32 v177, 0xffff0000, v126
    v_lshlrev_b32_e64 v178, 16, v127
    v_and_b32 v179, 0xffff0000, v127
    v_lshlrev_b32_e64 v180, 16, v128
    v_and_b32 v181, 0xffff0000, v128
    v_lshlrev_b32_e64 v182, 16, v129
    v_and_b32 v183, 0xffff0000, v129
    v_lshlrev_b32_e64 v184, 16, v130
    v_and_b32 v185, 0xffff0000, v130
    v_lshlrev_b32_e64 v186, 16, v131
    v_and_b32 v187, 0xffff0000, v131
    v_lshlrev_b32_e64 v188, 16, v132
    v_and_b32 v189, 0xffff0000, v132
    v_lshlrev_b32 v190, 16, v133
    v_and_b32 v191, 0xffff0000, v133
    s_add_u32 m0, s89, 102400
    s_movk_i32 s91, 640
    buffer_load_dwordx4 v12, s[48:51], s91 offen lds
    s_add_u32 m0, s89, 103424
    buffer_load_dwordx2 v[74:75], v9, s[56:59], 0 offen offset:2560
    buffer_load_dwordx4 v10, s[48:51], s91 offen lds
    buffer_load_dwordx4 v11, s[48:51], s91 offen offset:1024 lds
    s_add_u32 m0, s89, 105472
    s_nop 0
    buffer_load_dwordx4 v10, s[52:55], s91 offen lds
    buffer_load_dwordx4 v11, s[52:55], s91 offen offset:1024 lds
    s_waitcnt vmcnt(19)
    ds_read_b64_tr_b16 v[96:97], v16 offset:512
    ds_read_b64_tr_b16 v[98:99], v16 offset:1024
    ds_read_b64_tr_b16 v[100:101], v16 offset:1536
    ds_read_b64_tr_b16 v[102:103], v16 offset:2048
    ds_read_b64_tr_b16 v[104:105], v16 offset:2560
    ds_read_b64_tr_b16 v[106:107], v16 offset:3072
    ds_read_b64_tr_b16 v[108:109], v16 offset:3584
    ds_read_b64_tr_b16 v[110:111], v16 offset:4096
    ds_read_b64_tr_b16 v[112:113], v16 offset:4608
    v_add_u32 v16, 20480, v16
    v_pk_mul_f32 v[160:161], v[160:161], v[176:177]
    v_pk_mul_f32 v[162:163], v[162:163], v[178:179]
    v_pk_mul_f32 v[164:165], v[164:165], v[180:181]
    v_pk_mul_f32 v[166:167], v[166:167], v[182:183]
    v_pk_mul_f32 v[168:169], v[168:169], v[184:185]
    v_pk_mul_f32 v[170:171], v[170:171], v[186:187]
    v_pk_mul_f32 v[172:173], v[172:173], v[188:189]
    v_pk_mul_f32 v[174:175], v[174:175], v[190:191]
    v_cvt_pk_bf16_f32 v152, v160, v161
    v_cvt_pk_bf16_f32 v153, v162, v163
    v_cvt_pk_bf16_f32 v154, v164, v165
    v_cvt_pk_bf16_f32 v155, v166, v167
    v_cvt_pk_bf16_f32 v156, v168, v169
    v_cvt_pk_bf16_f32 v157, v170, v171
    v_cvt_pk_bf16_f32 v158, v172, v173
    v_cvt_pk_bf16_f32 v159, v174, v175
    ds_write_b128 v17, v[152:155] offset:8192
    ds_write_b128 v18, v[156:159] offset:8192
    s_waitcnt lgkmcnt(0)
    s_barrier
    ds_read_b128 v[200:203], v19 offset:8192
    ds_read_b128 v[204:207], v19 offset:9216
    v_alignbit_b32 v24, v69, v69, 16
    v_alignbit_b32 v25, v68, v68, 16
    v_and_b32 v26, 0xffff0000, v69
    v_and_b32 v28, 0xffff, v68
    v_alignbit_b32 v27, v25, v24, 16
    v_dot2_f32_bf16 v160, v96, v26, 0
    v_dot2_f32_bf16 v161, v97, v24, 0
    v_dot2_f32_bf16 v162, v97, v26, 0
    v_dot2_f32_bf16 v163, v98, v24, 0
    v_dot2_f32_bf16 v164, v98, v26, 0
    v_dot2_f32_bf16 v165, v99, v24, 0
    v_dot2_f32_bf16 v166, v99, v26, 0
    v_dot2_f32_bf16 v167, v100, v24, 0
    v_dot2_f32_bf16 v168, v100, v26, 0
    v_dot2_f32_bf16 v169, v101, v24, 0
    v_dot2_f32_bf16 v170, v101, v26, 0
    v_dot2_f32_bf16 v171, v102, v24, 0
    v_dot2_f32_bf16 v172, v102, v26, 0
    v_dot2_f32_bf16 v173, v103, v24, 0
    v_dot2_f32_bf16 v174, v103, v26, 0
    v_dot2_f32_bf16 v175, v104, v24, 0
    s_add_u32 m0, s89, 122880
    s_movk_i32 s91, 768
    buffer_load_dwordx4 v12, s[48:51], s91 offen lds
    s_add_u32 m0, s89, 123904
    buffer_load_dwordx2 v[76:77], v9, s[56:59], 0 offen offset:3072
    buffer_load_dwordx4 v10, s[48:51], s91 offen lds
    buffer_load_dwordx4 v11, s[48:51], s91 offen offset:1024 lds
    s_add_u32 m0, s89, 125952
    s_nop 0
    buffer_load_dwordx4 v10, s[52:55], s91 offen lds
    buffer_load_dwordx4 v11, s[52:55], s91 offen offset:1024 lds
    buffer_store_dwordx4 v[192:195], v20, s[84:87], s94 offen sc1
    buffer_store_dwordx4 v[196:199], v21, s[84:87], s94 offen sc1
    s_add_u32 s94, s94, 262144
    v_dot2c_f32_bf16 v160, v97, v27
    v_dot2c_f32_bf16 v161, v98, v25
    v_dot2c_f32_bf16 v162, v98, v27
    v_dot2c_f32_bf16 v163, v99, v25
    v_dot2c_f32_bf16 v164, v99, v27
    v_dot2c_f32_bf16 v165, v100, v25
    v_dot2c_f32_bf16 v166, v100, v27
    v_dot2c_f32_bf16 v167, v101, v25
    v_dot2c_f32_bf16 v168, v101, v27
    v_dot2c_f32_bf16 v169, v102, v25
    v_dot2c_f32_bf16 v170, v102, v27
    v_dot2c_f32_bf16 v171, v103, v25
    v_dot2c_f32_bf16 v172, v103, v27
    v_dot2c_f32_bf16 v173, v104, v25
    v_dot2c_f32_bf16 v174, v104, v27
    v_dot2c_f32_bf16 v175, v105, v25
    v_dot2c_f32_bf16 v160, v98, v28
    v_dot2c_f32_bf16 v162, v99, v28
    v_dot2c_f32_bf16 v164, v100, v28
    v_dot2c_f32_bf16 v166, v101, v28
    v_dot2c_f32_bf16 v168, v102, v28
    v_dot2c_f32_bf16 v170, v103, v28
    v_dot2c_f32_bf16 v172, v104, v28
    v_dot2c_f32_bf16 v174, v105, v28
    v_lshlrev_b32_e64 v176, 16, v106
    v_and_b32 v177, 0xffff0000, v106
    v_lshlrev_b32_e64 v178, 16, v107
    v_and_b32 v179, 0xffff0000, v107
    v_lshlrev_b32_e64 v180, 16, v108
    v_and_b32 v181, 0xffff0000, v108
    v_lshlrev_b32_e64 v182, 16, v109
    v_and_b32 v183, 0xffff0000, v109
    v_lshlrev_b32_e64 v184, 16, v110
    v_and_b32 v185, 0xffff0000, v110
    v_lshlrev_b32_e64 v186, 16, v111
    v_and_b32 v187, 0xffff0000, v111
    v_lshlrev_b32_e64 v188, 16, v112
    v_and_b32 v189, 0xffff0000, v112
    v_lshlrev_b32 v190, 16, v113
    v_and_b32 v191, 0xffff0000, v113
    s_waitcnt vmcnt(21)
    ds_read_b64_tr_b16 v[116:117], v16 offset:512
    ds_read_b64_tr_b16 v[118:119], v16 offset:1024
    ds_read_b64_tr_b16 v[120:121], v16 offset:1536
    ds_read_b64_tr_b16 v[122:123], v16 offset:2048
    ds_read_b64_tr_b16 v[124:125], v16 offset:2560
    ds_read_b64_tr_b16 v[126:127], v16 offset:3072
    ds_read_b64_tr_b16 v[128:129], v16 offset:3584
    ds_read_b64_tr_b16 v[130:131], v16 offset:4096
    ds_read_b64_tr_b16 v[132:133], v16 offset:4608
    v_add_u32 v16, 20480, v16
    v_pk_mul_f32 v[160:161], v[160:161], v[176:177]
    v_pk_mul_f32 v[162:163], v[162:163], v[178:179]
    v_pk_mul_f32 v[164:165], v[164:165], v[180:181]
    v_pk_mul_f32 v[166:167], v[166:167], v[182:183]
    v_pk_mul_f32 v[168:169], v[168:169], v[184:185]
    v_pk_mul_f32 v[170:171], v[170:171], v[186:187]
    v_pk_mul_f32 v[172:173], v[172:173], v[188:189]
    v_pk_mul_f32 v[174:175], v[174:175], v[190:191]
    v_cvt_pk_bf16_f32 v152, v160, v161
    v_cvt_pk_bf16_f32 v153, v162, v163
    v_cvt_pk_bf16_f32 v154, v164, v165
    v_cvt_pk_bf16_f32 v155, v166, v167
    v_cvt_pk_bf16_f32 v156, v168, v169
    v_cvt_pk_bf16_f32 v157, v170, v171
    v_cvt_pk_bf16_f32 v158, v172, v173
    v_cvt_pk_bf16_f32 v159, v174, v175
    ds_write_b128 v17, v[152:155] offset:0
    ds_write_b128 v18, v[156:159] offset:0
    s_waitcnt lgkmcnt(0)
    s_barrier
    ds_read_b128 v[208:211], v19 offset:0
    ds_read_b128 v[212:215], v19 offset:1024
    v_alignbit_b32 v24, v71, v71, 16
    v_alignbit_b32 v25, v70, v70, 16
    v_and_b32 v26, 0xffff0000, v71
    v_and_b32 v28, 0xffff, v70
    v_alignbit_b32 v27, v25, v24, 16
    v_dot2_f32_bf16 v160, v116, v26, 0
    v_dot2_f32_bf16 v161, v117, v24, 0
    v_dot2_f32_bf16 v162, v117, v26, 0
    v_dot2_f32_bf16 v163, v118, v24, 0
    v_dot2_f32_bf16 v164, v118, v26, 0
    v_dot2_f32_bf16 v165, v119, v24, 0
    v_dot2_f32_bf16 v166, v119, v26, 0
    v_dot2_f32_bf16 v167, v120, v24, 0
    v_dot2_f32_bf16 v168, v120, v26, 0
    v_dot2_f32_bf16 v169, v121, v24, 0
    v_dot2_f32_bf16 v170, v121, v26, 0
    v_dot2_f32_bf16 v171, v122, v24, 0
    v_dot2_f32_bf16 v172, v122, v26, 0
    v_dot2_f32_bf16 v173, v123, v24, 0
    v_dot2_f32_bf16 v174, v123, v26, 0
    v_dot2_f32_bf16 v175, v124, v24, 0
    buffer_store_dwordx4 v[200:203], v20, s[84:87], s94 offen sc1
    buffer_store_dwordx4 v[204:207], v21, s[84:87], s94 offen sc1
    s_add_u32 s94, s94, 262144
    v_dot2c_f32_bf16 v160, v117, v27
    v_dot2c_f32_bf16 v161, v118, v25
    v_dot2c_f32_bf16 v162, v118, v27
    v_dot2c_f32_bf16 v163, v119, v25
    v_dot2c_f32_bf16 v164, v119, v27
    v_dot2c_f32_bf16 v165, v120, v25
    v_dot2c_f32_bf16 v166, v120, v27
    v_dot2c_f32_bf16 v167, v121, v25
    v_dot2c_f32_bf16 v168, v121, v27
    v_dot2c_f32_bf16 v169, v122, v25
    v_dot2c_f32_bf16 v170, v122, v27
    v_dot2c_f32_bf16 v171, v123, v25
    v_dot2c_f32_bf16 v172, v123, v27
    v_dot2c_f32_bf16 v173, v124, v25
    v_dot2c_f32_bf16 v174, v124, v27
    v_dot2c_f32_bf16 v175, v125, v25
    v_dot2c_f32_bf16 v160, v118, v28
    v_dot2c_f32_bf16 v162, v119, v28
    v_dot2c_f32_bf16 v164, v120, v28
    v_dot2c_f32_bf16 v166, v121, v28
    v_dot2c_f32_bf16 v168, v122, v28
    v_dot2c_f32_bf16 v170, v123, v28
    v_dot2c_f32_bf16 v172, v124, v28
    v_dot2c_f32_bf16 v174, v125, v28
    v_lshlrev_b32_e64 v176, 16, v126
    v_and_b32 v177, 0xffff0000, v126
    v_lshlrev_b32_e64 v178, 16, v127
    v_and_b32 v179, 0xffff0000, v127
    v_lshlrev_b32_e64 v180, 16, v128
    v_and_b32 v181, 0xffff0000, v128
    v_lshlrev_b32_e64 v182, 16, v129
    v_and_b32 v183, 0xffff0000, v129
    v_lshlrev_b32_e64 v184, 16, v130
    v_and_b32 v185, 0xffff0000, v130
    v_lshlrev_b32_e64 v186, 16, v131
    v_and_b32 v187, 0xffff0000, v131
    v_lshlrev_b32_e64 v188, 16, v132
    v_and_b32 v189, 0xffff0000, v132
    v_lshlrev_b32 v190, 16, v133
    v_and_b32 v191, 0xffff0000, v133
    s_waitcnt vmcnt(16)
    ds_read_b64_tr_b16 v[96:97], v16 offset:512
    ds_read_b64_tr_b16 v[98:99], v16 offset:1024
    ds_read_b64_tr_b16 v[100:101], v16 offset:1536
    ds_read_b64_tr_b16 v[102:103], v16 offset:2048
    ds_read_b64_tr_b16 v[104:105], v16 offset:2560
    ds_read_b64_tr_b16 v[106:107], v16 offset:3072
    ds_read_b64_tr_b16 v[108:109], v16 offset:3584
    ds_read_b64_tr_b16 v[110:111], v16 offset:4096
    ds_read_b64_tr_b16 v[112:113], v16 offset:4608
    v_add_u32 v16, 20480, v16
    v_pk_mul_f32 v[160:161], v[160:161], v[176:177]
    v_pk_mul_f32 v[162:163], v[162:163], v[178:179]
    v_pk_mul_f32 v[164:165], v[164:165], v[180:181]
    v_pk_mul_f32 v[166:167], v[166:167], v[182:183]
    v_pk_mul_f32 v[168:169], v[168:169], v[184:185]
    v_pk_mul_f32 v[170:171], v[170:171], v[186:187]
    v_pk_mul_f32 v[172:173], v[172:173], v[188:189]
    v_pk_mul_f32 v[174:175], v[174:175], v[190:191]
    v_cvt_pk_bf16_f32 v152, v160, v161
    v_cvt_pk_bf16_f32 v153, v162, v163
    v_cvt_pk_bf16_f32 v154, v164, v165
    v_cvt_pk_bf16_f32 v155, v166, v167
    v_cvt_pk_bf16_f32 v156, v168, v169
    v_cvt_pk_bf16_f32 v157, v170, v171
    v_cvt_pk_bf16_f32 v158, v172, v173
    v_cvt_pk_bf16_f32 v159, v174, v175
    ds_write_b128 v17, v[152:155] offset:8192
    ds_write_b128 v18, v[156:159] offset:8192
    s_waitcnt lgkmcnt(0)
    s_barrier
    ds_read_b128 v[216:219], v19 offset:8192
    ds_read_b128 v[220:223], v19 offset:9216
    v_alignbit_b32 v24, v73, v73, 16
    v_alignbit_b32 v25, v72, v72, 16
    v_and_b32 v26, 0xffff0000, v73
    v_and_b32 v28, 0xffff, v72
    v_alignbit_b32 v27, v25, v24, 16
    v_dot2_f32_bf16 v160, v96, v26, 0
    v_dot2_f32_bf16 v161, v97, v24, 0
    v_dot2_f32_bf16 v162, v97, v26, 0
    v_dot2_f32_bf16 v163, v98, v24, 0
    v_dot2_f32_bf16 v164, v98, v26, 0
    v_dot2_f32_bf16 v165, v99, v24, 0
    v_dot2_f32_bf16 v166, v99, v26, 0
    v_dot2_f32_bf16 v167, v100, v24, 0
    v_dot2_f32_bf16 v168, v100, v26, 0
    v_dot2_f32_bf16 v169, v101, v24, 0
    v_dot2_f32_bf16 v170, v101, v26, 0
    v_dot2_f32_bf16 v171, v102, v24, 0
    v_dot2_f32_bf16 v172, v102, v26, 0
    v_dot2_f32_bf16 v173, v103, v24, 0
    v_dot2_f32_bf16 v174, v103, v26, 0
    v_dot2_f32_bf16 v175, v104, v24, 0
    buffer_store_dwordx4 v[208:211], v20, s[84:87], s94 offen sc1
    buffer_store_dwordx4 v[212:215], v21, s[84:87], s94 offen sc1
    s_add_u32 s94, s94, 262144
    v_dot2c_f32_bf16 v160, v97, v27
    v_dot2c_f32_bf16 v161, v98, v25
    v_dot2c_f32_bf16 v162, v98, v27
    v_dot2c_f32_bf16 v163, v99, v25
    v_dot2c_f32_bf16 v164, v99, v27
    v_dot2c_f32_bf16 v165, v100, v25
    v_dot2c_f32_bf16 v166, v100, v27
    v_dot2c_f32_bf16 v167, v101, v25
    v_dot2c_f32_bf16 v168, v101, v27
    v_dot2c_f32_bf16 v169, v102, v25
    v_dot2c_f32_bf16 v170, v102, v27
    v_dot2c_f32_bf16 v171, v103, v25
    v_dot2c_f32_bf16 v172, v103, v27
    v_dot2c_f32_bf16 v173, v104, v25
    v_dot2c_f32_bf16 v174, v104, v27
    v_dot2c_f32_bf16 v175, v105, v25
    v_dot2c_f32_bf16 v160, v98, v28
    v_dot2c_f32_bf16 v162, v99, v28
    v_dot2c_f32_bf16 v164, v100, v28
    v_dot2c_f32_bf16 v166, v101, v28
    v_dot2c_f32_bf16 v168, v102, v28
    v_dot2c_f32_bf16 v170, v103, v28
    v_dot2c_f32_bf16 v172, v104, v28
    v_dot2c_f32_bf16 v174, v105, v28
    v_lshlrev_b32_e64 v176, 16, v106
    v_and_b32 v177, 0xffff0000, v106
    v_lshlrev_b32_e64 v178, 16, v107
    v_and_b32 v179, 0xffff0000, v107
    v_lshlrev_b32_e64 v180, 16, v108
    v_and_b32 v181, 0xffff0000, v108
    v_lshlrev_b32_e64 v182, 16, v109
    v_and_b32 v183, 0xffff0000, v109
    v_lshlrev_b32_e64 v184, 16, v110
    v_and_b32 v185, 0xffff0000, v110
    v_lshlrev_b32_e64 v186, 16, v111
    v_and_b32 v187, 0xffff0000, v111
    v_lshlrev_b32_e64 v188, 16, v112
    v_and_b32 v189, 0xffff0000, v112
    v_lshlrev_b32 v190, 16, v113
    v_and_b32 v191, 0xffff0000, v113
    s_waitcnt vmcnt(12)
    ds_read_b64_tr_b16 v[116:117], v16 offset:512
    ds_read_b64_tr_b16 v[118:119], v16 offset:1024
    ds_read_b64_tr_b16 v[120:121], v16 offset:1536
    ds_read_b64_tr_b16 v[122:123], v16 offset:2048
    ds_read_b64_tr_b16 v[124:125], v16 offset:2560
    ds_read_b64_tr_b16 v[126:127], v16 offset:3072
    ds_read_b64_tr_b16 v[128:129], v16 offset:3584
    ds_read_b64_tr_b16 v[130:131], v16 offset:4096
    ds_read_b64_tr_b16 v[132:133], v16 offset:4608
    v_add_u32 v16, 20480, v16
    v_pk_mul_f32 v[160:161], v[160:161], v[176:177]
    v_pk_mul_f32 v[162:163], v[162:163], v[178:179]
    v_pk_mul_f32 v[164:165], v[164:165], v[180:181]
    v_pk_mul_f32 v[166:167], v[166:167], v[182:183]
    v_pk_mul_f32 v[168:169], v[168:169], v[184:185]
    v_pk_mul_f32 v[170:171], v[170:171], v[186:187]
    v_pk_mul_f32 v[172:173], v[172:173], v[188:189]
    v_pk_mul_f32 v[174:175], v[174:175], v[190:191]
    v_cvt_pk_bf16_f32 v152, v160, v161
    v_cvt_pk_bf16_f32 v153, v162, v163
    v_cvt_pk_bf16_f32 v154, v164, v165
    v_cvt_pk_bf16_f32 v155, v166, v167
    v_cvt_pk_bf16_f32 v156, v168, v169
    v_cvt_pk_bf16_f32 v157, v170, v171
    v_cvt_pk_bf16_f32 v158, v172, v173
    v_cvt_pk_bf16_f32 v159, v174, v175
    ds_write_b128 v17, v[152:155] offset:0
    ds_write_b128 v18, v[156:159] offset:0
    s_waitcnt lgkmcnt(0)
    s_barrier
    ds_read_b128 v[224:227], v19 offset:0
    ds_read_b128 v[228:231], v19 offset:1024
    v_alignbit_b32 v24, v75, v75, 16
    v_alignbit_b32 v25, v74, v74, 16
    v_and_b32 v26, 0xffff0000, v75
    v_and_b32 v28, 0xffff, v74
    v_alignbit_b32 v27, v25, v24, 16
    v_dot2_f32_bf16 v160, v116, v26, 0
    v_dot2_f32_bf16 v161, v117, v24, 0
    v_dot2_f32_bf16 v162, v117, v26, 0
    v_dot2_f32_bf16 v163, v118, v24, 0
    v_dot2_f32_bf16 v164, v118, v26, 0
    v_dot2_f32_bf16 v165, v119, v24, 0
    v_dot2_f32_bf16 v166, v119, v26, 0
    v_dot2_f32_bf16 v167, v120, v24, 0
    v_dot2_f32_bf16 v168, v120, v26, 0
    v_dot2_f32_bf16 v169, v121, v24, 0
    v_dot2_f32_bf16 v170, v121, v26, 0
    v_dot2_f32_bf16 v171, v122, v24, 0
    v_dot2_f32_bf16 v172, v122, v26, 0
    v_dot2_f32_bf16 v173, v123, v24, 0
    v_dot2_f32_bf16 v174, v123, v26, 0
    v_dot2_f32_bf16 v175, v124, v24, 0
    buffer_load_dword v40, off, s[80:83], 0 sc1
    buffer_store_dwordx4 v[216:219], v20, s[84:87], s94 offen sc1
    buffer_store_dwordx4 v[220:223], v21, s[84:87], s94 offen sc1
    s_add_u32 s94, s94, 262144
    v_dot2c_f32_bf16 v160, v117, v27
    v_dot2c_f32_bf16 v161, v118, v25
    v_dot2c_f32_bf16 v162, v118, v27
    v_dot2c_f32_bf16 v163, v119, v25
    v_dot2c_f32_bf16 v164, v119, v27
    v_dot2c_f32_bf16 v165, v120, v25
    v_dot2c_f32_bf16 v166, v120, v27
    v_dot2c_f32_bf16 v167, v121, v25
    v_dot2c_f32_bf16 v168, v121, v27
    v_dot2c_f32_bf16 v169, v122, v25
    v_dot2c_f32_bf16 v170, v122, v27
    v_dot2c_f32_bf16 v171, v123, v25
    v_dot2c_f32_bf16 v172, v123, v27
    v_dot2c_f32_bf16 v173, v124, v25
    v_dot2c_f32_bf16 v174, v124, v27
    v_dot2c_f32_bf16 v175, v125, v25
    v_dot2c_f32_bf16 v160, v118, v28
    v_dot2c_f32_bf16 v162, v119, v28
    v_dot2c_f32_bf16 v164, v120, v28
    v_dot2c_f32_bf16 v166, v121, v28
    v_dot2c_f32_bf16 v168, v122, v28
    v_dot2c_f32_bf16 v170, v123, v28
    v_dot2c_f32_bf16 v172, v124, v28
    v_dot2c_f32_bf16 v174, v125, v28
    v_lshlrev_b32_e64 v176, 16, v126
    v_and_b32 v177, 0xffff0000, v126
    v_lshlrev_b32_e64 v178, 16, v127
    v_and_b32 v179, 0xffff0000, v127
    v_lshlrev_b32_e64 v180, 16, v128
    v_and_b32 v181, 0xffff0000, v128
    v_lshlrev_b32_e64 v182, 16, v129
    v_and_b32 v183, 0xffff0000, v129
    v_lshlrev_b32_e64 v184, 16, v130
    v_and_b32 v185, 0xffff0000, v130
    v_lshlrev_b32_e64 v186, 16, v131
    v_and_b32 v187, 0xffff0000, v131
    v_lshlrev_b32_e64 v188, 16, v132
    v_and_b32 v189, 0xffff0000, v132
    v_lshlrev_b32 v190, 16, v133
    v_and_b32 v191, 0xffff0000, v133
    s_waitcnt vmcnt(9)
    ds_read_b64_tr_b16 v[96:97], v16 offset:512
    ds_read_b64_tr_b16 v[98:99], v16 offset:1024
    ds_read_b64_tr_b16 v[100:101], v16 offset:1536
    ds_read_b64_tr_b16 v[102:103], v16 offset:2048
    ds_read_b64_tr_b16 v[104:105], v16 offset:2560
    ds_read_b64_tr_b16 v[106:107], v16 offset:3072
    ds_read_b64_tr_b16 v[108:109], v16 offset:3584
    ds_read_b64_tr_b16 v[110:111], v16 offset:4096
    ds_read_b64_tr_b16 v[112:113], v16 offset:4608
    v_add_u32 v16, 20480, v16
    v_pk_mul_f32 v[160:161], v[160:161], v[176:177]
    v_pk_mul_f32 v[162:163], v[162:163], v[178:179]
    v_pk_mul_f32 v[164:165], v[164:165], v[180:181]
    v_pk_mul_f32 v[166:167], v[166:167], v[182:183]
    v_pk_mul_f32 v[168:169], v[168:169], v[184:185]
    v_pk_mul_f32 v[170:171], v[170:171], v[186:187]
    v_pk_mul_f32 v[172:173], v[172:173], v[188:189]
    v_pk_mul_f32 v[174:175], v[174:175], v[190:191]
    v_cvt_pk_bf16_f32 v152, v160, v161
    v_cvt_pk_bf16_f32 v153, v162, v163
    v_cvt_pk_bf16_f32 v154, v164, v165
    v_cvt_pk_bf16_f32 v155, v166, v167
    v_cvt_pk_bf16_f32 v156, v168, v169
    v_cvt_pk_bf16_f32 v157, v170, v171
    v_cvt_pk_bf16_f32 v158, v172, v173
    v_cvt_pk_bf16_f32 v159, v174, v175
    ds_write_b128 v17, v[152:155] offset:8192
    ds_write_b128 v18, v[156:159] offset:8192
    s_waitcnt lgkmcnt(0)
    s_barrier
    ds_read_b128 v[232:235], v19 offset:8192
    ds_read_b128 v[236:239], v19 offset:9216
    v_alignbit_b32 v24, v77, v77, 16
    v_alignbit_b32 v25, v76, v76, 16
    v_and_b32 v26, 0xffff0000, v77
    v_and_b32 v28, 0xffff, v76
    v_alignbit_b32 v27, v25, v24, 16
    v_dot2_f32_bf16 v160, v96, v26, 0
    v_dot2_f32_bf16 v161, v97, v24, 0
    v_dot2_f32_bf16 v162, v97, v26, 0
    v_dot2_f32_bf16 v163, v98, v24, 0
    v_dot2_f32_bf16 v164, v98, v26, 0
    v_dot2_f32_bf16 v165, v99, v24, 0
    v_dot2_f32_bf16 v166, v99, v26, 0
    v_dot2_f32_bf16 v167, v100, v24, 0
    v_dot2_f32_bf16 v168, v100, v26, 0
    v_dot2_f32_bf16 v169, v101, v24, 0
    v_dot2_f32_bf16 v170, v101, v26, 0
    v_dot2_f32_bf16 v171, v102, v24, 0
    v_dot2_f32_bf16 v172, v102, v26, 0
    v_dot2_f32_bf16 v173, v103, v24, 0
    v_dot2_f32_bf16 v174, v103, v26, 0
    v_dot2_f32_bf16 v175, v104, v24, 0
    buffer_store_dwordx4 v[224:227], v20, s[84:87], s94 offen sc1
    buffer_store_dwordx4 v[228:231], v21, s[84:87], s94 offen sc1
    s_add_u32 s94, s94, 262144
    v_dot2c_f32_bf16 v160, v97, v27
    v_dot2c_f32_bf16 v161, v98, v25
    v_dot2c_f32_bf16 v162, v98, v27
    v_dot2c_f32_bf16 v163, v99, v25
    v_dot2c_f32_bf16 v164, v99, v27
    v_dot2c_f32_bf16 v165, v100, v25
    v_dot2c_f32_bf16 v166, v100, v27
    v_dot2c_f32_bf16 v167, v101, v25
    v_dot2c_f32_bf16 v168, v101, v27
    v_dot2c_f32_bf16 v169, v102, v25
    v_dot2c_f32_bf16 v170, v102, v27
    v_dot2c_f32_bf16 v171, v103, v25
    v_dot2c_f32_bf16 v172, v103, v27
    v_dot2c_f32_bf16 v173, v104, v25
    v_dot2c_f32_bf16 v174, v104, v27
    v_dot2c_f32_bf16 v175, v105, v25
    v_dot2c_f32_bf16 v160, v98, v28
    v_dot2c_f32_bf16 v162, v99, v28
    v_dot2c_f32_bf16 v164, v100, v28
    v_dot2c_f32_bf16 v166, v101, v28
    v_dot2c_f32_bf16 v168, v102, v28
    v_dot2c_f32_bf16 v170, v103, v28
    v_dot2c_f32_bf16 v172, v104, v28
    v_dot2c_f32_bf16 v174, v105, v28
    v_lshlrev_b32_e64 v176, 16, v106
    v_and_b32 v177, 0xffff0000, v106
    v_lshlrev_b32_e64 v178, 16, v107
    v_and_b32 v179, 0xffff0000, v107
    v_lshlrev_b32_e64 v180, 16, v108
    v_and_b32 v181, 0xffff0000, v108
    v_lshlrev_b32_e64 v182, 16, v109
    v_and_b32 v183, 0xffff0000, v109
    v_lshlrev_b32_e64 v184, 16, v110
    v_and_b32 v185, 0xffff0000, v110
    v_lshlrev_b32_e64 v186, 16, v111
    v_and_b32 v187, 0xffff0000, v111
    v_lshlrev_b32_e64 v188, 16, v112
    v_and_b32 v189, 0xffff0000, v112
    v_lshlrev_b32 v190, 16, v113
    v_and_b32 v191, 0xffff0000, v113
    s_waitcnt lgkmcnt(0)
    buffer_store_dwordx4 v[232:235], v20, s[84:87], s94 offen sc1
    buffer_store_dwordx4 v[236:239], v21, s[84:87], s94 offen sc1
    s_add_u32 s94, s94, 262144
    v_pk_mul_f32 v[160:161], v[160:161], v[176:177]
    v_pk_mul_f32 v[162:163], v[162:163], v[178:179]
    v_pk_mul_f32 v[164:165], v[164:165], v[180:181]
    v_pk_mul_f32 v[166:167], v[166:167], v[182:183]
    v_pk_mul_f32 v[168:169], v[168:169], v[184:185]
    v_pk_mul_f32 v[170:171], v[170:171], v[186:187]
    v_pk_mul_f32 v[172:173], v[172:173], v[188:189]
    v_pk_mul_f32 v[174:175], v[174:175], v[190:191]
    v_cvt_pk_bf16_f32 v152, v160, v161
    v_cvt_pk_bf16_f32 v153, v162, v163
    v_cvt_pk_bf16_f32 v154, v164, v165
    v_cvt_pk_bf16_f32 v155, v166, v167
    v_cvt_pk_bf16_f32 v156, v168, v169
    v_cvt_pk_bf16_f32 v157, v170, v171
    v_cvt_pk_bf16_f32 v158, v172, v173
    v_cvt_pk_bf16_f32 v159, v174, v175
    ds_write_b128 v17, v[152:155] offset:0
    ds_write_b128 v18, v[156:159] offset:0
    s_waitcnt lgkmcnt(0)
    s_barrier
    ds_read_b128 v[240:243], v19 offset:0
    ds_read_b128 v[244:247], v19 offset:1024
    s_waitcnt lgkmcnt(0)
    buffer_store_dwordx4 v[240:243], v20, s[84:87], s94 offen sc1
    buffer_store_dwordx4 v[244:247], v21, s[84:87], s94 offen sc1
    s_add_u32 s94, s94, 262144
    s_waitcnt vmcnt(8)
    v_cmp_gt_u32 vcc, 1, v40
    s_mov_b32 s95, 0
    s_cbranch_vccnz Lslow5
Lback5:
    s_waitcnt vmcnt(0) lgkmcnt(0)
    s_barrier
    v_mov_b32 v2, 1
    buffer_store_dword v2, v39, s[84:87], 0 offen sc1
    s_endpgm
.section .rodata,"a"
.p2align 6
.amdhsa_kernel recurrent_scan__ssm_conv_h3__swiglu_ffn__prompt_kernel
  .amdhsa_next_free_vgpr 512
  .amdhsa_next_free_sgpr 102
  .amdhsa_accum_offset 256
  .amdhsa_group_segment_fixed_size 0
  .amdhsa_kernarg_size 104
  .amdhsa_user_sgpr_count 2
  .amdhsa_user_sgpr_kernarg_segment_ptr 1
  .amdhsa_system_sgpr_workgroup_id_x 1
  .amdhsa_float_denorm_mode_32 3
.end_amdhsa_kernel
```
